```python
import torch

def _softmax(x, axis=-1):
    return torch.softmax(x, dim=axis)

def _gelu(x):
    return torch.nn.functional.gelu(x, approximate='tanh')

def _silu(x):
    return torch.nn.functional.silu(x)

def _sigmoid(x):
    return torch.sigmoid(x)

def _layernorm(x, axis=-1, eps=1e-05):
    m = x.mean(dim=axis, keepdim=True)
    v = x.var(dim=axis, keepdim=True, unbiased=False)
    return (x - m) / torch.sqrt(v + eps)

def _scatter_add(tgt, idx, src, axis=0):
    return tgt.clone().index_add_(axis, idx, src)

def _segment_sum(src, seg, n):
    out = torch.zeros((n,) + src.shape[1:], dtype=src.dtype)
    return out.index_add_(0, seg, src)

def _pad(x, pw):
    flat = tuple((v for pair in reversed(pw) for v in pair))
    return torch.nn.functional.pad(x, flat)
kernel_name = 'adaLN_cond__mha_block__glu_gated_swiglu__prompt'

def setup_inputs():

    _w = lambda a: (lambda t: t.to(torch.bfloat16) if t.is_floating_point() else t)(torch.as_tensor(a))

    def _A_setup():
        B, S, D, H = (1, 2048, 512, 32)
        return {'x': _w((lambda *s: torch.randn(*s, dtype=torch.bfloat16) * 0.05)(B, S, D)), 'wqkv': _w((lambda *s: torch.randn(*s, dtype=torch.bfloat16) * 0.05)(D, 3 * D)), 'wo': _w((lambda *s: torch.randn(*s, dtype=torch.bfloat16) * 0.05)(D, D))}
    _A_in = _A_setup()

    def _B_setup():
        B, S, D, F = (1, 2048, 512, 1376)
        return {'x': _w((lambda *s: torch.randn(*s, dtype=torch.bfloat16) * 0.05)(B, S, D)), 'w1': _w((lambda *s: torch.randn(*s, dtype=torch.bfloat16) * 0.8)(D, F) * (2.0 / D) ** 0.5), 'w3': _w((lambda *s: torch.randn(*s, dtype=torch.bfloat16) * 0.8)(D, F) * (2.0 / D) ** 0.5), 'w2': _w((lambda *s: torch.randn(*s, dtype=torch.bfloat16) * 0.8)(F, D) * (2.0 / F) ** 0.5)}
    _B_in = _B_setup()
    return {'A_x': _A_in['x'], 'A_wqkv': _A_in['wqkv'], 'A_wo': _A_in['wo'], 'B_x': _B_in['x'], 'B_w1': _B_in['w1'], 'B_w3': _B_in['w3'], 'B_w2': _B_in['w2'], 'c': _w((lambda *s: torch.randn(*s, dtype=torch.bfloat16) * 0.2)(1, 512) * 8.0), 'w_mod': _w((lambda *s: torch.randn(*s, dtype=torch.bfloat16) * 0.2)(512, 6 * 512) * 512 ** (-0.5) * 8.0)}

def reference(A_x, A_wqkv, A_wo, B_x, B_w1, B_w3, B_w2, c, w_mod):

    def _A_ref(x, wqkv, wo):
        B, S, D = x.shape
        H = 32
        Dh = D // H
        qkv = (lambda x, *d: x.permute(*d))((x @ wqkv).reshape(B, S, 3, H, Dh), 2, 0, 3, 1, 4)
        q, k, v = (qkv[0], qkv[1], qkv[2])
        scores = torch.einsum('bhqd,bhkd->bhqk', q, k) * Dh ** (-0.5)
        p = _softmax(scores, axis=-1)
        o = torch.einsum('bhqk,bhkd->bhqd', p, v)
        return (lambda x, *d: x.permute(*d))(o, 0, 2, 1, 3).reshape(B, S, D) @ wo

    def _B_ref(x, w1, w3, w2):
        gate = torch.einsum('bsd,df->bsf', x, w1)
        up = torch.einsum('bsd,df->bsf', x, w3)
        h = _silu(gate) * up
        out = torch.einsum('bsf,fd->bsd', h, w2)
        return out
    x = A_x
    mod = (_silu(c) @ w_mod).reshape(c.shape[0], 6, 1, -1)
    sa, ca, ga, sb, cb, gb = (mod[:, 0].clone(), mod[:, 1].clone(), mod[:, 2].clone(), mod[:, 3].clone(), mod[:, 4].clone(), mod[:, 5].clone())
    h = _layernorm(x, axis=-1) * (1 + ca) + sa
    x = x + ga * _A_ref(h, A_wqkv, A_wo)
    h = _layernorm(x, axis=-1) * (1 + cb) + sb
    x = x + gb * _B_ref(h, B_w1, B_w3, B_w2)
    return x
```

```asm
; @launch grid=(256,1,1) block=(512,1,1) lds=163840
.amdgcn_target "amdgcn-amd-amdhsa--gfx950"
.text
.globl adaLN_cond__mha_block__glu_gated_swiglu__prompt_kernel
.p2align 8
.type adaLN_cond__mha_block__glu_gated_swiglu__prompt_kernel,@function
adaLN_cond__mha_block__glu_gated_swiglu__prompt_kernel:
    s_cmp_ge_u32 s2, 256
    s_cbranch_scc1 PK_END
    s_load_dwordx16 s[64:79], s[0:1], 0
    s_load_dwordx8 s[80:87], s[0:1], 64
    v_lshrrev_b32 v1, 6, v0
    v_and_b32 v2, 63, v0
    v_readfirstlane_b32 s89, v1
    s_mov_b32 s90, s2
    s_getpc_b64 s[96:97]
PC_1:
    s_sub_u32 s96, s96, PC_1-adaLN_cond__mha_block__glu_gated_swiglu__prompt_kernel
    s_subb_u32 s97, s97, 0
    s_lshl_b32 s98, s89, 13
    v_lshlrev_b32 v246, 7, v2
    v_add_u32 v246, s98, v246
    v_min_u32 v246, PK_CODE_END-adaLN_cond__mha_block__glu_gated_swiglu__prompt_kernel-4, v246
    global_load_dword v245, v246, s[96:97]
    s_lshr_b32 s98, s2, 3
    s_lshl_b32 s98, s98, 2
    s_and_b32 s99, s2, 3
    s_add_u32 s98, s98, s99
    s_add_u32 s99, s98, 128
    s_cmp_lt_u32 s98, 64
    s_cselect_b32 s91, s98, s99
    s_add_u32 s99, s98, 64
    s_bitcmp1_b32 s2, 2
    s_cselect_b32 s91, s99, s91
    v_lshlrev_b32 v3, 4, v2
    s_mov_b32 s88, 0
    s_waitcnt lgkmcnt(0)
    v_mov_b32 v250, 0
    s_cmp_eq_u32 s89, 0
    s_cbranch_scc0 PK_NONONCE
    s_cmp_eq_u32 s90, 0
    s_cbranch_scc0 PK_LDNONCE
    s_memrealtime s[96:97]
    s_waitcnt lgkmcnt(0)
    s_or_b32 s88, s96, 1
    v_mov_b32 v251, s88
    s_mov_b64 exec, 1
    global_store_dword v250, v251, s[84:85] sc1
    s_mov_b64 exec, -1
    s_branch PK_NONONCE
PK_LDNONCE:
    global_load_dword v249, v250, s[84:85] sc1
PK_NONONCE:
    s_add_u32 s92, s86, 0x30000
    s_addc_u32 s93, s87, 0
    s_mov_b32 s94, 0x38000
    s_mov_b32 s95, 0x20000
    s_cmp_ge_u32 s91, 192
    s_cbranch_scc1 P1_H
    s_cmp_ge_u32 s91, 64
    s_cselect_b32 s37, 1, 0
    s_cbranch_scc1 P1_NC
    s_lshr_b32 s20, s91, 4
    s_and_b32 s21, s91, 15
    s_branch P1_GEMV
P1_NC:
    s_cmp_ge_u32 s91, 128
    s_cbranch_scc1 P1_NC2
    s_sub_u32 s22, s91, 64
    s_lshr_b32 s20, s22, 4
    s_and_b32 s21, s22, 15
    s_add_u32 s21, s21, 24
    s_branch P1_WQONLY
P1_NC2:
    s_sub_u32 s22, s91, 128
    s_lshr_b32 s20, s22, 4
    s_and_b32 s21, s22, 15
    s_cmp_ge_u32 s21, 8
    s_cselect_b32 s23, 32, 16
    s_add_u32 s21, s21, s23
    s_branch P1_WQ
P1_GEMV:
    s_mov_b32 s8, s80
    s_mov_b32 s9, s81
    s_mov_b32 s10, 0x300000
    s_mov_b32 s11, 0x20000
    s_mov_b32 s12, s78
    s_mov_b32 s13, s79
    s_mov_b32 s14, 0x400
    s_mov_b32 s15, 0x20000
    v_lshrrev_b32 v4, 3, v2
    v_and_b32 v5, 7, v2
    v_mul_u32_u24 v6, 6144, v4
    v_lshl_add_u32 v6, v5, 4, v6
    v_lshlrev_b32 v7, 1, v4
    s_lshl_b32 s22, s20, 7
    s_lshl_b32 s23, s89, 4
    s_add_u32 s22, s22, s23
    s_lshl_b32 s23, s22, 1
    buffer_load_ushort v16, v7, s[12:15], s23 offen
    buffer_load_ushort v17, v7, s[12:15], s23 offen offset:16
    s_mul_i32 s22, s22, 6144
    s_lshl_b32 s23, s21, 7
    s_add_u32 s22, s22, s23
    buffer_load_dwordx4 v[20:23], v6, s[8:11], s22 offen
    s_add_u32 s22, s22, 49152
    buffer_load_dwordx4 v[24:27], v6, s[8:11], s22 offen
    s_add_u32 s22, s22, -46080
    buffer_load_dwordx4 v[28:31], v6, s[8:11], s22 offen
    s_add_u32 s22, s22, 49152
    buffer_load_dwordx4 v[32:35], v6, s[8:11], s22 offen
    v_lshrrev_b32 v56, 4, v0
    v_lshlrev_b32 v56, 8, v56
    v_lshl_add_u32 v56, v5, 5, v56
    v_lshlrev_b32 v57, 2, v2
    s_waitcnt vmcnt(4)
    global_load_dword v249, v250, s[84:85] sc1
    v_lshlrev_b32 v16, 16, v16
    v_mul_f32 v18, 0xbfb8aa3b, v16
    v_lshlrev_b32 v17, 16, v17
    v_mul_f32 v19, 0xbfb8aa3b, v17
    v_exp_f32 v18, v18
    v_exp_f32 v19, v19
    v_add_f32 v18, 1.0, v18
    v_add_f32 v19, 1.0, v19
    v_rcp_f32 v18, v18
    v_rcp_f32 v19, v19
    v_mul_f32 v16, v16, v18
    v_mul_f32 v17, v17, v19
    v_cvt_pk_bf16_f32 v16, v16, v16
    v_cvt_pk_bf16_f32 v17, v17, v17
    v_lshlrev_b32 v16, 16, v16
    v_lshlrev_b32 v17, 16, v17
    s_waitcnt vmcnt(3)
    v_lshlrev_b32 v58, 16, v20
    v_and_b32 v59, 0xffff0000, v20
    v_lshlrev_b32 v60, 16, v21
    v_and_b32 v61, 0xffff0000, v21
    v_lshlrev_b32 v62, 16, v22
    v_and_b32 v63, 0xffff0000, v22
    v_lshlrev_b32 v64, 16, v23
    v_and_b32 v65, 0xffff0000, v23
    v_mul_f32 v48, v58, v16
    v_mul_f32 v49, v59, v16
    v_mul_f32 v50, v60, v16
    v_mul_f32 v51, v61, v16
    v_mul_f32 v52, v62, v16
    v_mul_f32 v53, v63, v16
    v_mul_f32 v54, v64, v16
    v_mul_f32 v55, v65, v16
    v_lshlrev_b32 v58, 16, v24
    v_and_b32 v59, 0xffff0000, v24
    v_lshlrev_b32 v60, 16, v25
    v_and_b32 v61, 0xffff0000, v25
    v_lshlrev_b32 v62, 16, v26
    v_and_b32 v63, 0xffff0000, v26
    v_lshlrev_b32 v64, 16, v27
    v_and_b32 v65, 0xffff0000, v27
    v_fmac_f32 v48, v58, v17
    v_fmac_f32 v49, v59, v17
    v_fmac_f32 v50, v60, v17
    v_fmac_f32 v51, v61, v17
    v_fmac_f32 v52, v62, v17
    v_fmac_f32 v53, v63, v17
    v_fmac_f32 v54, v64, v17
    v_fmac_f32 v55, v65, v17
    v_add_f32_dpp v48, v48, v48 row_ror:8 row_mask:0xf bank_mask:0xf
    v_add_f32_dpp v49, v49, v49 row_ror:8 row_mask:0xf bank_mask:0xf
    v_add_f32_dpp v50, v50, v50 row_ror:8 row_mask:0xf bank_mask:0xf
    v_add_f32_dpp v51, v51, v51 row_ror:8 row_mask:0xf bank_mask:0xf
    v_add_f32_dpp v52, v52, v52 row_ror:8 row_mask:0xf bank_mask:0xf
    v_add_f32_dpp v53, v53, v53 row_ror:8 row_mask:0xf bank_mask:0xf
    v_add_f32_dpp v54, v54, v54 row_ror:8 row_mask:0xf bank_mask:0xf
    v_add_f32_dpp v55, v55, v55 row_ror:8 row_mask:0xf bank_mask:0xf
    ds_write_b128 v56, v[48:51]
    ds_write_b128 v56, v[52:55] offset:16
    s_waitcnt lgkmcnt(0)
    s_barrier
    s_cmp_eq_u32 s89, 0
    s_cbranch_scc0 P1E_GPUB
    ds_read_b32 v64, v57 offset:0
    ds_read_b32 v65, v57 offset:256
    ds_read_b32 v66, v57 offset:512
    ds_read_b32 v67, v57 offset:768
    ds_read_b32 v68, v57 offset:1024
    ds_read_b32 v69, v57 offset:1280
    ds_read_b32 v70, v57 offset:1536
    ds_read_b32 v71, v57 offset:1792
    ds_read_b32 v72, v57 offset:2048
    ds_read_b32 v73, v57 offset:2304
    ds_read_b32 v74, v57 offset:2560
    ds_read_b32 v75, v57 offset:2816
    ds_read_b32 v76, v57 offset:3072
    ds_read_b32 v77, v57 offset:3328
    ds_read_b32 v78, v57 offset:3584
    ds_read_b32 v79, v57 offset:3840
    ds_read_b32 v80, v57 offset:4096
    ds_read_b32 v81, v57 offset:4352
    ds_read_b32 v82, v57 offset:4608
    ds_read_b32 v83, v57 offset:4864
    ds_read_b32 v84, v57 offset:5120
    ds_read_b32 v85, v57 offset:5376
    ds_read_b32 v86, v57 offset:5632
    ds_read_b32 v87, v57 offset:5888
    ds_read_b32 v88, v57 offset:6144
    ds_read_b32 v89, v57 offset:6400
    ds_read_b32 v90, v57 offset:6656
    ds_read_b32 v91, v57 offset:6912
    ds_read_b32 v92, v57 offset:7168
    ds_read_b32 v93, v57 offset:7424
    ds_read_b32 v94, v57 offset:7680
    ds_read_b32 v95, v57 offset:7936
    s_cmp_lg_u32 s88, 0
    s_cbranch_scc1 NONCE_2_OK
    s_waitcnt vmcnt(0)
    v_readfirstlane_b32 s88, v249
    s_nop 1
    s_cmp_lg_u32 s88, 0
    s_cbranch_scc1 NONCE_2_OK
    s_mov_b32 s98, 0
NONCE_2_L:
    v_mov_b32 v250, 0
    global_load_dword v251, v250, s[84:85] sc1
    s_waitcnt vmcnt(0)
    v_readfirstlane_b32 s88, v251
    s_add_u32 s98, s98, 1
    s_cmp_gt_u32 s98, 0x4000
    s_cbranch_scc1 NONCE_2_OK
    s_cmp_eq_u32 s88, 0
    s_cbranch_scc1 NONCE_2_L
NONCE_2_OK:
    s_waitcnt lgkmcnt(0)
    v_add_f32 v64, v64, v80
    v_add_f32 v65, v65, v81
    v_add_f32 v66, v66, v82
    v_add_f32 v67, v67, v83
    v_add_f32 v68, v68, v84
    v_add_f32 v69, v69, v85
    v_add_f32 v70, v70, v86
    v_add_f32 v71, v71, v87
    v_add_f32 v72, v72, v88
    v_add_f32 v73, v73, v89
    v_add_f32 v74, v74, v90
    v_add_f32 v75, v75, v91
    v_add_f32 v76, v76, v92
    v_add_f32 v77, v77, v93
    v_add_f32 v78, v78, v94
    v_add_f32 v79, v79, v95
    v_add_f32 v64, v64, v72
    v_add_f32 v65, v65, v73
    v_add_f32 v66, v66, v74
    v_add_f32 v67, v67, v75
    v_add_f32 v68, v68, v76
    v_add_f32 v69, v69, v77
    v_add_f32 v70, v70, v78
    v_add_f32 v71, v71, v79
    v_add_f32 v64, v64, v68
    v_add_f32 v65, v65, v69
    v_add_f32 v66, v66, v70
    v_add_f32 v67, v67, v71
    v_add_f32 v64, v64, v66
    v_add_f32 v65, v65, v67
    v_add_f32 v64, v64, v65
    s_cmp_lt_u32 s21, 16
    s_cbranch_scc0 P1E_GPLAIN
    s_add_u32 s8, s86, 0x10000
    s_addc_u32 s9, s87, 0
    s_mov_b32 s10, 0x8000
    s_mov_b32 s11, 0x20000
    v_mov_b32 v65, s88
    s_lshl_b32 s22, s20, 13
    s_lshl_b32 s23, s21, 9
    s_add_u32 s22, s22, s23
    v_lshlrev_b32 v57, 3, v2
    buffer_store_dwordx2 v[64:65], v57, s[8:11], s22 offen sc1
    s_branch P1E_GPUB
P1E_GPLAIN:
    s_mov_b32 s8, s86
    s_mov_b32 s9, s87
    s_mov_b32 s10, 0xc000
    s_mov_b32 s11, 0x20000
    s_mul_i32 s22, s20, 12288
    s_lshl_b32 s23, s21, 8
    s_add_u32 s22, s22, s23
    buffer_store_dword v64, v57, s[8:11], s22 offen sc1
    s_mul_i32 s22, s20, 48
    s_add_u32 s22, s22, s21
    s_add_u32 s22, s22, 0
    s_waitcnt vmcnt(0)
    s_cmp_lg_u32 s88, 0
    s_cbranch_scc1 NONCE_3_OK
    s_waitcnt vmcnt(0)
    v_readfirstlane_b32 s88, v249
    s_nop 1
    s_cmp_lg_u32 s88, 0
    s_cbranch_scc1 NONCE_3_OK
    s_mov_b32 s98, 0
NONCE_3_L:
    v_mov_b32 v250, 0
    global_load_dword v251, v250, s[84:85] sc1
    s_waitcnt vmcnt(0)
    v_readfirstlane_b32 s88, v251
    s_add_u32 s98, s98, 1
    s_cmp_gt_u32 s98, 0x4000
    s_cbranch_scc1 NONCE_3_OK
    s_cmp_eq_u32 s88, 0
    s_cbranch_scc1 NONCE_3_L
NONCE_3_OK:
    s_lshl_b32 s98, s22, 7
    v_mov_b32 v250, s98
    v_mov_b32 v251, s88
    s_mov_b64 exec, 1
    buffer_store_dword v251, v250, s[92:95], 0 offen sc1
    s_mov_b64 exec, -1
P1E_GPUB:
    s_waitcnt vmcnt(1)
    v_lshlrev_b32 v36, 16, v28
    v_and_b32 v37, 0xffff0000, v28
    v_lshlrev_b32 v38, 16, v29
    v_and_b32 v39, 0xffff0000, v29
    v_lshlrev_b32 v40, 16, v30
    v_and_b32 v41, 0xffff0000, v30
    v_lshlrev_b32 v42, 16, v31
    v_and_b32 v43, 0xffff0000, v31
    v_mul_f32 v48, v36, v16
    v_mul_f32 v49, v37, v16
    v_mul_f32 v50, v38, v16
    v_mul_f32 v51, v39, v16
    v_mul_f32 v52, v40, v16
    v_mul_f32 v53, v41, v16
    v_mul_f32 v54, v42, v16
    v_mul_f32 v55, v43, v16
    v_lshlrev_b32 v36, 16, v32
    v_and_b32 v37, 0xffff0000, v32
    v_lshlrev_b32 v38, 16, v33
    v_and_b32 v39, 0xffff0000, v33
    v_lshlrev_b32 v40, 16, v34
    v_and_b32 v41, 0xffff0000, v34
    v_lshlrev_b32 v42, 16, v35
    v_and_b32 v43, 0xffff0000, v35
    v_fmac_f32 v48, v36, v17
    v_fmac_f32 v49, v37, v17
    v_fmac_f32 v50, v38, v17
    v_fmac_f32 v51, v39, v17
    v_fmac_f32 v52, v40, v17
    v_fmac_f32 v53, v41, v17
    v_fmac_f32 v54, v42, v17
    v_fmac_f32 v55, v43, v17
    v_add_f32_dpp v48, v48, v48 row_ror:8 row_mask:0xf bank_mask:0xf
    v_add_f32_dpp v49, v49, v49 row_ror:8 row_mask:0xf bank_mask:0xf
    v_add_f32_dpp v50, v50, v50 row_ror:8 row_mask:0xf bank_mask:0xf
    v_add_f32_dpp v51, v51, v51 row_ror:8 row_mask:0xf bank_mask:0xf
    v_add_f32_dpp v52, v52, v52 row_ror:8 row_mask:0xf bank_mask:0xf
    v_add_f32_dpp v53, v53, v53 row_ror:8 row_mask:0xf bank_mask:0xf
    v_add_f32_dpp v54, v54, v54 row_ror:8 row_mask:0xf bank_mask:0xf
    v_add_f32_dpp v55, v55, v55 row_ror:8 row_mask:0xf bank_mask:0xf
    ds_write_b128 v56, v[48:51] offset:8192
    ds_write_b128 v56, v[52:55] offset:8208
    s_waitcnt lgkmcnt(0)
    s_barrier
    s_cmp_eq_u32 s89, 0
    s_cbranch_scc0 P1E_G2PUB
    v_lshlrev_b32 v57, 2, v2
    ds_read_b32 v64, v57 offset:8192
    ds_read_b32 v65, v57 offset:8448
    ds_read_b32 v66, v57 offset:8704
    ds_read_b32 v67, v57 offset:8960
    ds_read_b32 v68, v57 offset:9216
    ds_read_b32 v69, v57 offset:9472
    ds_read_b32 v70, v57 offset:9728
    ds_read_b32 v71, v57 offset:9984
    ds_read_b32 v72, v57 offset:10240
    ds_read_b32 v73, v57 offset:10496
    ds_read_b32 v74, v57 offset:10752
    ds_read_b32 v75, v57 offset:11008
    ds_read_b32 v76, v57 offset:11264
    ds_read_b32 v77, v57 offset:11520
    ds_read_b32 v78, v57 offset:11776
    ds_read_b32 v79, v57 offset:12032
    ds_read_b32 v80, v57 offset:12288
    ds_read_b32 v81, v57 offset:12544
    ds_read_b32 v82, v57 offset:12800
    ds_read_b32 v83, v57 offset:13056
    ds_read_b32 v84, v57 offset:13312
    ds_read_b32 v85, v57 offset:13568
    ds_read_b32 v86, v57 offset:13824
    ds_read_b32 v87, v57 offset:14080
    ds_read_b32 v88, v57 offset:14336
    ds_read_b32 v89, v57 offset:14592
    ds_read_b32 v90, v57 offset:14848
    ds_read_b32 v91, v57 offset:15104
    ds_read_b32 v92, v57 offset:15360
    ds_read_b32 v93, v57 offset:15616
    ds_read_b32 v94, v57 offset:15872
    ds_read_b32 v95, v57 offset:16128
    s_waitcnt lgkmcnt(0)
    v_add_f32 v64, v64, v80
    v_add_f32 v65, v65, v81
    v_add_f32 v66, v66, v82
    v_add_f32 v67, v67, v83
    v_add_f32 v68, v68, v84
    v_add_f32 v69, v69, v85
    v_add_f32 v70, v70, v86
    v_add_f32 v71, v71, v87
    v_add_f32 v72, v72, v88
    v_add_f32 v73, v73, v89
    v_add_f32 v74, v74, v90
    v_add_f32 v75, v75, v91
    v_add_f32 v76, v76, v92
    v_add_f32 v77, v77, v93
    v_add_f32 v78, v78, v94
    v_add_f32 v79, v79, v95
    v_add_f32 v64, v64, v72
    v_add_f32 v65, v65, v73
    v_add_f32 v66, v66, v74
    v_add_f32 v67, v67, v75
    v_add_f32 v68, v68, v76
    v_add_f32 v69, v69, v77
    v_add_f32 v70, v70, v78
    v_add_f32 v71, v71, v79
    v_add_f32 v64, v64, v68
    v_add_f32 v65, v65, v69
    v_add_f32 v66, v66, v70
    v_add_f32 v67, v67, v71
    v_add_f32 v64, v64, v66
    v_add_f32 v65, v65, v67
    v_add_f32 v64, v64, v65
    s_mov_b32 s8, s86
    s_mov_b32 s9, s87
    s_mov_b32 s10, 0xc000
    s_mov_b32 s11, 0x20000
    s_mul_i32 s22, s20, 12288
    s_add_u32 s25, s21, 24
    s_lshl_b32 s23, s25, 8
    s_add_u32 s22, s22, s23
    buffer_store_dword v64, v57, s[8:11], s22 offen sc1
    s_mul_i32 s22, s20, 48
    s_add_u32 s22, s22, s25
    s_add_u32 s22, s22, 0
    s_waitcnt vmcnt(0)
    s_cmp_lg_u32 s88, 0
    s_cbranch_scc1 NONCE_4_OK
    s_waitcnt vmcnt(0)
    v_readfirstlane_b32 s88, v249
    s_nop 1
    s_cmp_lg_u32 s88, 0
    s_cbranch_scc1 NONCE_4_OK
    s_mov_b32 s98, 0
NONCE_4_L:
    v_mov_b32 v250, 0
    global_load_dword v251, v250, s[84:85] sc1
    s_waitcnt vmcnt(0)
    v_readfirstlane_b32 s88, v251
    s_add_u32 s98, s98, 1
    s_cmp_gt_u32 s98, 0x4000
    s_cbranch_scc1 NONCE_4_OK
    s_cmp_eq_u32 s88, 0
    s_cbranch_scc1 NONCE_4_L
NONCE_4_OK:
    s_lshl_b32 s98, s22, 7
    v_mov_b32 v250, s98
    v_mov_b32 v251, s88
    s_mov_b64 exec, 1
    buffer_store_dword v251, v250, s[92:95], 0 offen sc1
    s_mov_b64 exec, -1
P1E_G2PUB:
    s_lshr_b32 s59, s90, 3
    s_and_b32 s56, s90, 3
    s_lshl_b32 s56, s56, 2
    s_and_b32 s57, s59, 3
    s_add_u32 s56, s56, s57
    s_lshr_b32 s57, s59, 2
    s_and_b32 s58, s90, 4
    s_add_u32 s57, s57, s58
    s_mov_b32 s60, s66
    s_mov_b32 s61, s67
    s_mov_b32 s62, 0x180000
    s_mov_b32 s63, 0x20000
    v_and_b32 v224, 7, v2
    v_bfe_u32 v225, v2, 3, 1
    v_lshrrev_b32 v226, 4, v2
    v_lshlrev_b32 v227, 4, v226
    v_lshl_add_u32 v227, v225, 3, v227
    v_mul_u32_u24 v227, 3072, v227
    v_lshl_add_u32 v227, v224, 4, v227
    s_mul_i32 s58, s89, 196608
    s_lshl_b32 s59, s57, 8
    s_add_u32 s58, s58, s59
    buffer_load_dwordx4 v[128:131], v227, s[60:63], s58 offen offset:0
    buffer_load_dwordx4 v[160:163], v227, s[60:63], s58 offen offset:128
    s_add_u32 s58, s58, 3072
    buffer_load_dwordx4 v[132:135], v227, s[60:63], s58 offen offset:0
    buffer_load_dwordx4 v[164:167], v227, s[60:63], s58 offen offset:128
    s_add_u32 s58, s58, 3072
    buffer_load_dwordx4 v[136:139], v227, s[60:63], s58 offen offset:0
    buffer_load_dwordx4 v[168:171], v227, s[60:63], s58 offen offset:128
    s_add_u32 s58, s58, 3072
    buffer_load_dwordx4 v[140:143], v227, s[60:63], s58 offen offset:0
    buffer_load_dwordx4 v[172:175], v227, s[60:63], s58 offen offset:128
    s_add_u32 s58, s58, 3072
    buffer_load_dwordx4 v[144:147], v227, s[60:63], s58 offen offset:0
    buffer_load_dwordx4 v[176:179], v227, s[60:63], s58 offen offset:128
    s_add_u32 s58, s58, 3072
    buffer_load_dwordx4 v[148:151], v227, s[60:63], s58 offen offset:0
    buffer_load_dwordx4 v[180:183], v227, s[60:63], s58 offen offset:128
    s_add_u32 s58, s58, 3072
    buffer_load_dwordx4 v[152:155], v227, s[60:63], s58 offen offset:0
    buffer_load_dwordx4 v[184:187], v227, s[60:63], s58 offen offset:128
    s_add_u32 s58, s58, 3072
    buffer_load_dwordx4 v[156:159], v227, s[60:63], s58 offen offset:0
    buffer_load_dwordx4 v[188:191], v227, s[60:63], s58 offen offset:128
    v_lshlrev_b32 v228, 12, v226
    v_lshrrev_b32 v229, 2, v224
    v_lshl_add_u32 v228, v229, 10, v228
    v_lshl_add_u32 v228, v225, 9, v228
    v_and_b32 v229, 3, v224
    v_lshl_add_u32 v228, v229, 7, v228
    s_lshl_b32 s58, s89, 14
    s_add_u32 s58, s58, 32768
    v_add_u32 v228, s58, v228
    v_mov_b32 v229, v224
    v_lshlrev_b32 v229, 4, v229
    v_xor_b32 v230, 0, v229
    v_add_u32 v230, v230, v228
    v_xor_b32 v231, 16, v229
    v_add_u32 v231, v231, v228
    v_xor_b32 v232, 32, v229
    v_add_u32 v232, v232, v228
    v_xor_b32 v233, 48, v229
    v_add_u32 v233, v233, v228
    v_xor_b32 v234, 64, v229
    v_add_u32 v234, v234, v228
    v_xor_b32 v235, 80, v229
    v_add_u32 v235, v235, v228
    v_xor_b32 v236, 96, v229
    v_add_u32 v236, v236, v228
    v_xor_b32 v237, 112, v229
    v_add_u32 v237, v237, v228
    s_mov_b32 s58, 0x05040100
    s_mov_b32 s59, 0x07060302
    s_waitcnt vmcnt(0)
    v_perm_b32 v192, v132, v128, s58
    v_perm_b32 v193, v140, v136, s58
    v_perm_b32 v194, v148, v144, s58
    v_perm_b32 v195, v156, v152, s58
    v_perm_b32 v196, v132, v128, s59
    v_perm_b32 v197, v140, v136, s59
    v_perm_b32 v198, v148, v144, s59
    v_perm_b32 v199, v156, v152, s59
    v_perm_b32 v200, v133, v129, s58
    v_perm_b32 v201, v141, v137, s58
    v_perm_b32 v202, v149, v145, s58
    v_perm_b32 v203, v157, v153, s58
    v_perm_b32 v204, v133, v129, s59
    v_perm_b32 v205, v141, v137, s59
    v_perm_b32 v206, v149, v145, s59
    v_perm_b32 v207, v157, v153, s59
    v_perm_b32 v208, v134, v130, s58
    v_perm_b32 v209, v142, v138, s58
    v_perm_b32 v210, v150, v146, s58
    v_perm_b32 v211, v158, v154, s58
    v_perm_b32 v212, v134, v130, s59
    v_perm_b32 v213, v142, v138, s59
    v_perm_b32 v214, v150, v146, s59
    v_perm_b32 v215, v158, v154, s59
    v_perm_b32 v216, v135, v131, s58
    v_perm_b32 v217, v143, v139, s58
    v_perm_b32 v218, v151, v147, s58
    v_perm_b32 v219, v159, v155, s58
    v_perm_b32 v220, v135, v131, s59
    v_perm_b32 v221, v143, v139, s59
    v_perm_b32 v222, v151, v147, s59
    v_perm_b32 v223, v159, v155, s59
    ds_write_b128 v230, v[192:195] offset:0
    ds_write_b128 v231, v[196:199] offset:0
    ds_write_b128 v232, v[200:203] offset:0
    ds_write_b128 v233, v[204:207] offset:0
    ds_write_b128 v234, v[208:211] offset:0
    ds_write_b128 v235, v[212:215] offset:0
    ds_write_b128 v236, v[216:219] offset:0
    ds_write_b128 v237, v[220:223] offset:0
    s_nop 0
    v_perm_b32 v192, v164, v160, s58
    v_perm_b32 v193, v172, v168, s58
    v_perm_b32 v194, v180, v176, s58
    v_perm_b32 v195, v188, v184, s58
    v_perm_b32 v196, v164, v160, s59
    v_perm_b32 v197, v172, v168, s59
    v_perm_b32 v198, v180, v176, s59
    v_perm_b32 v199, v188, v184, s59
    v_perm_b32 v200, v165, v161, s58
    v_perm_b32 v201, v173, v169, s58
    v_perm_b32 v202, v181, v177, s58
    v_perm_b32 v203, v189, v185, s58
    v_perm_b32 v204, v165, v161, s59
    v_perm_b32 v205, v173, v169, s59
    v_perm_b32 v206, v181, v177, s59
    v_perm_b32 v207, v189, v185, s59
    v_perm_b32 v208, v166, v162, s58
    v_perm_b32 v209, v174, v170, s58
    v_perm_b32 v210, v182, v178, s58
    v_perm_b32 v211, v190, v186, s58
    v_perm_b32 v212, v166, v162, s59
    v_perm_b32 v213, v174, v170, s59
    v_perm_b32 v214, v182, v178, s59
    v_perm_b32 v215, v190, v186, s59
    v_perm_b32 v216, v167, v163, s58
    v_perm_b32 v217, v175, v171, s58
    v_perm_b32 v218, v183, v179, s58
    v_perm_b32 v219, v191, v187, s58
    v_perm_b32 v220, v167, v163, s59
    v_perm_b32 v221, v175, v171, s59
    v_perm_b32 v222, v183, v179, s59
    v_perm_b32 v223, v191, v187, s59
    ds_write_b128 v230, v[192:195] offset:2048
    ds_write_b128 v231, v[196:199] offset:2048
    ds_write_b128 v232, v[200:203] offset:2048
    ds_write_b128 v233, v[204:207] offset:2048
    ds_write_b128 v234, v[208:211] offset:2048
    ds_write_b128 v235, v[212:215] offset:2048
    ds_write_b128 v236, v[216:219] offset:2048
    ds_write_b128 v237, v[220:223] offset:2048
    s_branch P1_DONE
P1_WQONLY:
    s_lshr_b32 s59, s90, 3
    s_and_b32 s56, s90, 3
    s_lshl_b32 s56, s56, 2
    s_and_b32 s57, s59, 3
    s_add_u32 s56, s56, s57
    s_lshr_b32 s57, s59, 2
    s_and_b32 s58, s90, 4
    s_add_u32 s57, s57, s58
    s_mov_b32 s60, s66
    s_mov_b32 s61, s67
    s_mov_b32 s62, 0x180000
    s_mov_b32 s63, 0x20000
    v_and_b32 v224, 7, v2
    v_bfe_u32 v225, v2, 3, 1
    v_lshrrev_b32 v226, 4, v2
    v_lshlrev_b32 v227, 4, v226
    v_lshl_add_u32 v227, v225, 3, v227
    v_mul_u32_u24 v227, 3072, v227
    v_lshl_add_u32 v227, v224, 4, v227
    s_mul_i32 s58, s89, 196608
    s_lshl_b32 s59, s57, 8
    s_add_u32 s58, s58, s59
    buffer_load_dwordx4 v[128:131], v227, s[60:63], s58 offen offset:0
    buffer_load_dwordx4 v[160:163], v227, s[60:63], s58 offen offset:128
    s_add_u32 s58, s58, 3072
    buffer_load_dwordx4 v[132:135], v227, s[60:63], s58 offen offset:0
    buffer_load_dwordx4 v[164:167], v227, s[60:63], s58 offen offset:128
    s_add_u32 s58, s58, 3072
    buffer_load_dwordx4 v[136:139], v227, s[60:63], s58 offen offset:0
    buffer_load_dwordx4 v[168:171], v227, s[60:63], s58 offen offset:128
    s_add_u32 s58, s58, 3072
    buffer_load_dwordx4 v[140:143], v227, s[60:63], s58 offen offset:0
    buffer_load_dwordx4 v[172:175], v227, s[60:63], s58 offen offset:128
    s_add_u32 s58, s58, 3072
    buffer_load_dwordx4 v[144:147], v227, s[60:63], s58 offen offset:0
    buffer_load_dwordx4 v[176:179], v227, s[60:63], s58 offen offset:128
    s_add_u32 s58, s58, 3072
    buffer_load_dwordx4 v[148:151], v227, s[60:63], s58 offen offset:0
    buffer_load_dwordx4 v[180:183], v227, s[60:63], s58 offen offset:128
    s_add_u32 s58, s58, 3072
    buffer_load_dwordx4 v[152:155], v227, s[60:63], s58 offen offset:0
    buffer_load_dwordx4 v[184:187], v227, s[60:63], s58 offen offset:128
    s_add_u32 s58, s58, 3072
    buffer_load_dwordx4 v[156:159], v227, s[60:63], s58 offen offset:0
    buffer_load_dwordx4 v[188:191], v227, s[60:63], s58 offen offset:128
    s_sub_u32 s48, s91, 64
    s_lshl_b32 s48, s48, 3
    s_add_u32 s48, s48, s89
    s_mov_b32 s49, 0
    s_mov_b32 s50, s72
    s_mov_b32 s51, s73
    s_cmp_ge_u32 s48, 172
    s_cselect_b32 s50, s74, s50
    s_cselect_b32 s51, s75, s51
    s_cselect_b32 s49, 172, s49
    s_cmp_ge_u32 s48, 344
    s_cselect_b32 s50, s76, s50
    s_cselect_b32 s51, s77, s51
    s_cselect_b32 s49, 344, s49
    s_cmp_ge_u32 s48, 516
    s_cselect_b32 s50, s68, s50
    s_cselect_b32 s51, s69, s51
    s_cselect_b32 s49, 516, s49
    s_sub_u32 s49, s48, s49
    s_cmp_ge_u32 s48, 580
    s_cselect_b32 s49, 0, s49
    s_lshl_b32 s49, s49, 13
    v_lshlrev_b32 v244, 7, v2
    v_add_u32 v244, s49, v244
    global_load_dword v243, v244, s[50:51]
    v_lshlrev_b32 v228, 12, v226
    v_lshrrev_b32 v229, 2, v224
    v_lshl_add_u32 v228, v229, 10, v228
    v_lshl_add_u32 v228, v225, 9, v228
    v_and_b32 v229, 3, v224
    v_lshl_add_u32 v228, v229, 7, v228
    s_lshl_b32 s58, s89, 14
    s_add_u32 s58, s58, 32768
    v_add_u32 v228, s58, v228
    v_mov_b32 v229, v224
    v_lshlrev_b32 v229, 4, v229
    v_xor_b32 v230, 0, v229
    v_add_u32 v230, v230, v228
    v_xor_b32 v231, 16, v229
    v_add_u32 v231, v231, v228
    v_xor_b32 v232, 32, v229
    v_add_u32 v232, v232, v228
    v_xor_b32 v233, 48, v229
    v_add_u32 v233, v233, v228
    v_xor_b32 v234, 64, v229
    v_add_u32 v234, v234, v228
    v_xor_b32 v235, 80, v229
    v_add_u32 v235, v235, v228
    v_xor_b32 v236, 96, v229
    v_add_u32 v236, v236, v228
    v_xor_b32 v237, 112, v229
    v_add_u32 v237, v237, v228
    s_mov_b32 s58, 0x05040100
    s_mov_b32 s59, 0x07060302
    s_waitcnt vmcnt(1)
    v_perm_b32 v192, v132, v128, s58
    v_perm_b32 v193, v140, v136, s58
    v_perm_b32 v194, v148, v144, s58
    v_perm_b32 v195, v156, v152, s58
    v_perm_b32 v196, v132, v128, s59
    v_perm_b32 v197, v140, v136, s59
    v_perm_b32 v198, v148, v144, s59
    v_perm_b32 v199, v156, v152, s59
    v_perm_b32 v200, v133, v129, s58
    v_perm_b32 v201, v141, v137, s58
    v_perm_b32 v202, v149, v145, s58
    v_perm_b32 v203, v157, v153, s58
    v_perm_b32 v204, v133, v129, s59
    v_perm_b32 v205, v141, v137, s59
    v_perm_b32 v206, v149, v145, s59
    v_perm_b32 v207, v157, v153, s59
    v_perm_b32 v208, v134, v130, s58
    v_perm_b32 v209, v142, v138, s58
    v_perm_b32 v210, v150, v146, s58
    v_perm_b32 v211, v158, v154, s58
    v_perm_b32 v212, v134, v130, s59
    v_perm_b32 v213, v142, v138, s59
    v_perm_b32 v214, v150, v146, s59
    v_perm_b32 v215, v158, v154, s59
    v_perm_b32 v216, v135, v131, s58
    v_perm_b32 v217, v143, v139, s58
    v_perm_b32 v218, v151, v147, s58
    v_perm_b32 v219, v159, v155, s58
    v_perm_b32 v220, v135, v131, s59
    v_perm_b32 v221, v143, v139, s59
    v_perm_b32 v222, v151, v147, s59
    v_perm_b32 v223, v159, v155, s59
    ds_write_b128 v230, v[192:195] offset:0
    ds_write_b128 v231, v[196:199] offset:0
    ds_write_b128 v232, v[200:203] offset:0
    ds_write_b128 v233, v[204:207] offset:0
    ds_write_b128 v234, v[208:211] offset:0
    ds_write_b128 v235, v[212:215] offset:0
    ds_write_b128 v236, v[216:219] offset:0
    ds_write_b128 v237, v[220:223] offset:0
    s_nop 0
    v_perm_b32 v192, v164, v160, s58
    v_perm_b32 v193, v172, v168, s58
    v_perm_b32 v194, v180, v176, s58
    v_perm_b32 v195, v188, v184, s58
    v_perm_b32 v196, v164, v160, s59
    v_perm_b32 v197, v172, v168, s59
    v_perm_b32 v198, v180, v176, s59
    v_perm_b32 v199, v188, v184, s59
    v_perm_b32 v200, v165, v161, s58
    v_perm_b32 v201, v173, v169, s58
    v_perm_b32 v202, v181, v177, s58
    v_perm_b32 v203, v189, v185, s58
    v_perm_b32 v204, v165, v161, s59
    v_perm_b32 v205, v173, v169, s59
    v_perm_b32 v206, v181, v177, s59
    v_perm_b32 v207, v189, v185, s59
    v_perm_b32 v208, v166, v162, s58
    v_perm_b32 v209, v174, v170, s58
    v_perm_b32 v210, v182, v178, s58
    v_perm_b32 v211, v190, v186, s58
    v_perm_b32 v212, v166, v162, s59
    v_perm_b32 v213, v174, v170, s59
    v_perm_b32 v214, v182, v178, s59
    v_perm_b32 v215, v190, v186, s59
    v_perm_b32 v216, v167, v163, s58
    v_perm_b32 v217, v175, v171, s58
    v_perm_b32 v218, v183, v179, s58
    v_perm_b32 v219, v191, v187, s58
    v_perm_b32 v220, v167, v163, s59
    v_perm_b32 v221, v175, v171, s59
    v_perm_b32 v222, v183, v179, s59
    v_perm_b32 v223, v191, v187, s59
    ds_write_b128 v230, v[192:195] offset:2048
    ds_write_b128 v231, v[196:199] offset:2048
    ds_write_b128 v232, v[200:203] offset:2048
    ds_write_b128 v233, v[204:207] offset:2048
    ds_write_b128 v234, v[208:211] offset:2048
    ds_write_b128 v235, v[212:215] offset:2048
    ds_write_b128 v236, v[216:219] offset:2048
    ds_write_b128 v237, v[220:223] offset:2048
    s_branch P1_DONE
P1_WQ:
    s_mov_b32 s8, s80
    s_mov_b32 s9, s81
    s_mov_b32 s10, 0x300000
    s_mov_b32 s11, 0x20000
    s_mov_b32 s12, s78
    s_mov_b32 s13, s79
    s_mov_b32 s14, 0x400
    s_mov_b32 s15, 0x20000
    v_lshrrev_b32 v4, 3, v2
    v_and_b32 v5, 7, v2
    v_mul_u32_u24 v6, 6144, v4
    v_lshl_add_u32 v6, v5, 4, v6
    v_lshlrev_b32 v7, 1, v4
    s_lshl_b32 s22, s20, 7
    s_lshl_b32 s23, s89, 4
    s_add_u32 s22, s22, s23
    s_lshl_b32 s23, s22, 1
    buffer_load_ushort v16, v7, s[12:15], s23 offen
    buffer_load_ushort v17, v7, s[12:15], s23 offen offset:16
    s_mul_i32 s22, s22, 6144
    s_lshl_b32 s23, s21, 7
    s_add_u32 s22, s22, s23
    buffer_load_dwordx4 v[20:23], v6, s[8:11], s22 offen
    s_add_u32 s22, s22, 49152
    buffer_load_dwordx4 v[24:27], v6, s[8:11], s22 offen
    s_lshr_b32 s59, s90, 3
    s_and_b32 s56, s90, 3
    s_lshl_b32 s56, s56, 2
    s_and_b32 s57, s59, 3
    s_add_u32 s56, s56, s57
    s_lshr_b32 s57, s59, 2
    s_and_b32 s58, s90, 4
    s_add_u32 s57, s57, s58
    s_mov_b32 s60, s66
    s_mov_b32 s61, s67
    s_mov_b32 s62, 0x180000
    s_mov_b32 s63, 0x20000
    v_and_b32 v224, 7, v2
    v_bfe_u32 v225, v2, 3, 1
    v_lshrrev_b32 v226, 4, v2
    v_lshlrev_b32 v227, 4, v226
    v_lshl_add_u32 v227, v225, 3, v227
    v_mul_u32_u24 v227, 3072, v227
    v_lshl_add_u32 v227, v224, 4, v227
    s_mul_i32 s58, s89, 196608
    s_lshl_b32 s59, s57, 8
    s_add_u32 s58, s58, s59
    buffer_load_dwordx4 v[128:131], v227, s[60:63], s58 offen offset:0
    buffer_load_dwordx4 v[160:163], v227, s[60:63], s58 offen offset:128
    s_add_u32 s58, s58, 3072
    buffer_load_dwordx4 v[132:135], v227, s[60:63], s58 offen offset:0
    buffer_load_dwordx4 v[164:167], v227, s[60:63], s58 offen offset:128
    s_add_u32 s58, s58, 3072
    buffer_load_dwordx4 v[136:139], v227, s[60:63], s58 offen offset:0
    buffer_load_dwordx4 v[168:171], v227, s[60:63], s58 offen offset:128
    s_add_u32 s58, s58, 3072
    buffer_load_dwordx4 v[140:143], v227, s[60:63], s58 offen offset:0
    buffer_load_dwordx4 v[172:175], v227, s[60:63], s58 offen offset:128
    s_add_u32 s58, s58, 3072
    buffer_load_dwordx4 v[144:147], v227, s[60:63], s58 offen offset:0
    buffer_load_dwordx4 v[176:179], v227, s[60:63], s58 offen offset:128
    s_add_u32 s58, s58, 3072
    buffer_load_dwordx4 v[148:151], v227, s[60:63], s58 offen offset:0
    buffer_load_dwordx4 v[180:183], v227, s[60:63], s58 offen offset:128
    s_add_u32 s58, s58, 3072
    buffer_load_dwordx4 v[152:155], v227, s[60:63], s58 offen offset:0
    buffer_load_dwordx4 v[184:187], v227, s[60:63], s58 offen offset:128
    s_add_u32 s58, s58, 3072
    buffer_load_dwordx4 v[156:159], v227, s[60:63], s58 offen offset:0
    buffer_load_dwordx4 v[188:191], v227, s[60:63], s58 offen offset:128
    s_sub_u32 s48, s91, 64
    s_lshl_b32 s48, s48, 3
    s_add_u32 s48, s48, s89
    s_mov_b32 s49, 0
    s_mov_b32 s50, s72
    s_mov_b32 s51, s73
    s_cmp_ge_u32 s48, 172
    s_cselect_b32 s50, s74, s50
    s_cselect_b32 s51, s75, s51
    s_cselect_b32 s49, 172, s49
    s_cmp_ge_u32 s48, 344
    s_cselect_b32 s50, s76, s50
    s_cselect_b32 s51, s77, s51
    s_cselect_b32 s49, 344, s49
    s_cmp_ge_u32 s48, 516
    s_cselect_b32 s50, s68, s50
    s_cselect_b32 s51, s69, s51
    s_cselect_b32 s49, 516, s49
    s_sub_u32 s49, s48, s49
    s_cmp_ge_u32 s48, 580
    s_cselect_b32 s49, 0, s49
    s_lshl_b32 s49, s49, 13
    v_lshlrev_b32 v244, 7, v2
    v_add_u32 v244, s49, v244
    global_load_dword v243, v244, s[50:51]
    v_lshrrev_b32 v56, 4, v0
    v_lshlrev_b32 v56, 8, v56
    v_lshl_add_u32 v56, v5, 5, v56
    v_lshlrev_b32 v57, 2, v2
    s_waitcnt vmcnt(19)
    global_load_dword v249, v250, s[84:85] sc1
    v_lshlrev_b32 v16, 16, v16
    v_mul_f32 v18, 0xbfb8aa3b, v16
    v_lshlrev_b32 v17, 16, v17
    v_mul_f32 v19, 0xbfb8aa3b, v17
    v_exp_f32 v18, v18
    v_exp_f32 v19, v19
    v_add_f32 v18, 1.0, v18
    v_add_f32 v19, 1.0, v19
    v_rcp_f32 v18, v18
    v_rcp_f32 v19, v19
    v_mul_f32 v16, v16, v18
    v_mul_f32 v17, v17, v19
    v_cvt_pk_bf16_f32 v16, v16, v16
    v_cvt_pk_bf16_f32 v17, v17, v17
    v_lshlrev_b32 v16, 16, v16
    v_lshlrev_b32 v17, 16, v17
    s_waitcnt vmcnt(18)
    v_lshlrev_b32 v58, 16, v20
    v_and_b32 v59, 0xffff0000, v20
    v_lshlrev_b32 v60, 16, v21
    v_and_b32 v61, 0xffff0000, v21
    v_lshlrev_b32 v62, 16, v22
    v_and_b32 v63, 0xffff0000, v22
    v_lshlrev_b32 v64, 16, v23
    v_and_b32 v65, 0xffff0000, v23
    v_mul_f32 v48, v58, v16
    v_mul_f32 v49, v59, v16
    v_mul_f32 v50, v60, v16
    v_mul_f32 v51, v61, v16
    v_mul_f32 v52, v62, v16
    v_mul_f32 v53, v63, v16
    v_mul_f32 v54, v64, v16
    v_mul_f32 v55, v65, v16
    v_lshlrev_b32 v58, 16, v24
    v_and_b32 v59, 0xffff0000, v24
    v_lshlrev_b32 v60, 16, v25
    v_and_b32 v61, 0xffff0000, v25
    v_lshlrev_b32 v62, 16, v26
    v_and_b32 v63, 0xffff0000, v26
    v_lshlrev_b32 v64, 16, v27
    v_and_b32 v65, 0xffff0000, v27
    v_fmac_f32 v48, v58, v17
    v_fmac_f32 v49, v59, v17
    v_fmac_f32 v50, v60, v17
    v_fmac_f32 v51, v61, v17
    v_fmac_f32 v52, v62, v17
    v_fmac_f32 v53, v63, v17
    v_fmac_f32 v54, v64, v17
    v_fmac_f32 v55, v65, v17
    v_add_f32_dpp v48, v48, v48 row_ror:8 row_mask:0xf bank_mask:0xf
    v_add_f32_dpp v49, v49, v49 row_ror:8 row_mask:0xf bank_mask:0xf
    v_add_f32_dpp v50, v50, v50 row_ror:8 row_mask:0xf bank_mask:0xf
    v_add_f32_dpp v51, v51, v51 row_ror:8 row_mask:0xf bank_mask:0xf
    v_add_f32_dpp v52, v52, v52 row_ror:8 row_mask:0xf bank_mask:0xf
    v_add_f32_dpp v53, v53, v53 row_ror:8 row_mask:0xf bank_mask:0xf
    v_add_f32_dpp v54, v54, v54 row_ror:8 row_mask:0xf bank_mask:0xf
    v_add_f32_dpp v55, v55, v55 row_ror:8 row_mask:0xf bank_mask:0xf
    ds_write_b128 v56, v[48:51]
    ds_write_b128 v56, v[52:55] offset:16
    s_waitcnt lgkmcnt(0)
    s_barrier
    s_cmp_eq_u32 s89, 0
    s_cbranch_scc0 P1L_GPUB
    ds_read_b32 v64, v57 offset:0
    ds_read_b32 v65, v57 offset:256
    ds_read_b32 v66, v57 offset:512
    ds_read_b32 v67, v57 offset:768
    ds_read_b32 v68, v57 offset:1024
    ds_read_b32 v69, v57 offset:1280
    ds_read_b32 v70, v57 offset:1536
    ds_read_b32 v71, v57 offset:1792
    ds_read_b32 v72, v57 offset:2048
    ds_read_b32 v73, v57 offset:2304
    ds_read_b32 v74, v57 offset:2560
    ds_read_b32 v75, v57 offset:2816
    ds_read_b32 v76, v57 offset:3072
    ds_read_b32 v77, v57 offset:3328
    ds_read_b32 v78, v57 offset:3584
    ds_read_b32 v79, v57 offset:3840
    ds_read_b32 v80, v57 offset:4096
    ds_read_b32 v81, v57 offset:4352
    ds_read_b32 v82, v57 offset:4608
    ds_read_b32 v83, v57 offset:4864
    ds_read_b32 v84, v57 offset:5120
    ds_read_b32 v85, v57 offset:5376
    ds_read_b32 v86, v57 offset:5632
    ds_read_b32 v87, v57 offset:5888
    ds_read_b32 v88, v57 offset:6144
    ds_read_b32 v89, v57 offset:6400
    ds_read_b32 v90, v57 offset:6656
    ds_read_b32 v91, v57 offset:6912
    ds_read_b32 v92, v57 offset:7168
    ds_read_b32 v93, v57 offset:7424
    ds_read_b32 v94, v57 offset:7680
    ds_read_b32 v95, v57 offset:7936
    s_cmp_lg_u32 s88, 0
    s_cbranch_scc1 NONCE_5_OK
    s_waitcnt vmcnt(0)
    v_readfirstlane_b32 s88, v249
    s_nop 1
    s_cmp_lg_u32 s88, 0
    s_cbranch_scc1 NONCE_5_OK
    s_mov_b32 s98, 0
NONCE_5_L:
    v_mov_b32 v250, 0
    global_load_dword v251, v250, s[84:85] sc1
    s_waitcnt vmcnt(0)
    v_readfirstlane_b32 s88, v251
    s_add_u32 s98, s98, 1
    s_cmp_gt_u32 s98, 0x4000
    s_cbranch_scc1 NONCE_5_OK
    s_cmp_eq_u32 s88, 0
    s_cbranch_scc1 NONCE_5_L
NONCE_5_OK:
    s_waitcnt lgkmcnt(0)
    v_add_f32 v64, v64, v80
    v_add_f32 v65, v65, v81
    v_add_f32 v66, v66, v82
    v_add_f32 v67, v67, v83
    v_add_f32 v68, v68, v84
    v_add_f32 v69, v69, v85
    v_add_f32 v70, v70, v86
    v_add_f32 v71, v71, v87
    v_add_f32 v72, v72, v88
    v_add_f32 v73, v73, v89
    v_add_f32 v74, v74, v90
    v_add_f32 v75, v75, v91
    v_add_f32 v76, v76, v92
    v_add_f32 v77, v77, v93
    v_add_f32 v78, v78, v94
    v_add_f32 v79, v79, v95
    v_add_f32 v64, v64, v72
    v_add_f32 v65, v65, v73
    v_add_f32 v66, v66, v74
    v_add_f32 v67, v67, v75
    v_add_f32 v68, v68, v76
    v_add_f32 v69, v69, v77
    v_add_f32 v70, v70, v78
    v_add_f32 v71, v71, v79
    v_add_f32 v64, v64, v68
    v_add_f32 v65, v65, v69
    v_add_f32 v66, v66, v70
    v_add_f32 v67, v67, v71
    v_add_f32 v64, v64, v66
    v_add_f32 v65, v65, v67
    v_add_f32 v64, v64, v65
    s_cmp_lt_u32 s21, 16
    s_cbranch_scc0 P1L_GPLAIN
    s_add_u32 s8, s86, 0x10000
    s_addc_u32 s9, s87, 0
    s_mov_b32 s10, 0x8000
    s_mov_b32 s11, 0x20000
    v_mov_b32 v65, s88
    s_lshl_b32 s22, s20, 13
    s_lshl_b32 s23, s21, 9
    s_add_u32 s22, s22, s23
    v_lshlrev_b32 v57, 3, v2
    buffer_store_dwordx2 v[64:65], v57, s[8:11], s22 offen sc1
    s_branch P1L_GPUB
P1L_GPLAIN:
    s_mov_b32 s8, s86
    s_mov_b32 s9, s87
    s_mov_b32 s10, 0xc000
    s_mov_b32 s11, 0x20000
    s_mul_i32 s22, s20, 12288
    s_lshl_b32 s23, s21, 8
    s_add_u32 s22, s22, s23
    buffer_store_dword v64, v57, s[8:11], s22 offen sc1
    s_mul_i32 s22, s20, 48
    s_add_u32 s22, s22, s21
    s_add_u32 s22, s22, 0
    s_waitcnt vmcnt(0)
    s_cmp_lg_u32 s88, 0
    s_cbranch_scc1 NONCE_6_OK
    s_waitcnt vmcnt(0)
    v_readfirstlane_b32 s88, v249
    s_nop 1
    s_cmp_lg_u32 s88, 0
    s_cbranch_scc1 NONCE_6_OK
    s_mov_b32 s98, 0
NONCE_6_L:
    v_mov_b32 v250, 0
    global_load_dword v251, v250, s[84:85] sc1
    s_waitcnt vmcnt(0)
    v_readfirstlane_b32 s88, v251
    s_add_u32 s98, s98, 1
    s_cmp_gt_u32 s98, 0x4000
    s_cbranch_scc1 NONCE_6_OK
    s_cmp_eq_u32 s88, 0
    s_cbranch_scc1 NONCE_6_L
NONCE_6_OK:
    s_lshl_b32 s98, s22, 7
    v_mov_b32 v250, s98
    v_mov_b32 v251, s88
    s_mov_b64 exec, 1
    buffer_store_dword v251, v250, s[92:95], 0 offen sc1
    s_mov_b64 exec, -1
P1L_GPUB:
    v_lshlrev_b32 v228, 12, v226
    v_lshrrev_b32 v229, 2, v224
    v_lshl_add_u32 v228, v229, 10, v228
    v_lshl_add_u32 v228, v225, 9, v228
    v_and_b32 v229, 3, v224
    v_lshl_add_u32 v228, v229, 7, v228
    s_lshl_b32 s58, s89, 14
    s_add_u32 s58, s58, 32768
    v_add_u32 v228, s58, v228
    v_mov_b32 v229, v224
    v_lshlrev_b32 v229, 4, v229
    v_xor_b32 v230, 0, v229
    v_add_u32 v230, v230, v228
    v_xor_b32 v231, 16, v229
    v_add_u32 v231, v231, v228
    v_xor_b32 v232, 32, v229
    v_add_u32 v232, v232, v228
    v_xor_b32 v233, 48, v229
    v_add_u32 v233, v233, v228
    v_xor_b32 v234, 64, v229
    v_add_u32 v234, v234, v228
    v_xor_b32 v235, 80, v229
    v_add_u32 v235, v235, v228
    v_xor_b32 v236, 96, v229
    v_add_u32 v236, v236, v228
    v_xor_b32 v237, 112, v229
    v_add_u32 v237, v237, v228
    s_mov_b32 s58, 0x05040100
    s_mov_b32 s59, 0x07060302
    s_waitcnt vmcnt(0)
    v_perm_b32 v192, v132, v128, s58
    v_perm_b32 v193, v140, v136, s58
    v_perm_b32 v194, v148, v144, s58
    v_perm_b32 v195, v156, v152, s58
    v_perm_b32 v196, v132, v128, s59
    v_perm_b32 v197, v140, v136, s59
    v_perm_b32 v198, v148, v144, s59
    v_perm_b32 v199, v156, v152, s59
    v_perm_b32 v200, v133, v129, s58
    v_perm_b32 v201, v141, v137, s58
    v_perm_b32 v202, v149, v145, s58
    v_perm_b32 v203, v157, v153, s58
    v_perm_b32 v204, v133, v129, s59
    v_perm_b32 v205, v141, v137, s59
    v_perm_b32 v206, v149, v145, s59
    v_perm_b32 v207, v157, v153, s59
    v_perm_b32 v208, v134, v130, s58
    v_perm_b32 v209, v142, v138, s58
    v_perm_b32 v210, v150, v146, s58
    v_perm_b32 v211, v158, v154, s58
    v_perm_b32 v212, v134, v130, s59
    v_perm_b32 v213, v142, v138, s59
    v_perm_b32 v214, v150, v146, s59
    v_perm_b32 v215, v158, v154, s59
    v_perm_b32 v216, v135, v131, s58
    v_perm_b32 v217, v143, v139, s58
    v_perm_b32 v218, v151, v147, s58
    v_perm_b32 v219, v159, v155, s58
    v_perm_b32 v220, v135, v131, s59
    v_perm_b32 v221, v143, v139, s59
    v_perm_b32 v222, v151, v147, s59
    v_perm_b32 v223, v159, v155, s59
    ds_write_b128 v230, v[192:195] offset:0
    ds_write_b128 v231, v[196:199] offset:0
    ds_write_b128 v232, v[200:203] offset:0
    ds_write_b128 v233, v[204:207] offset:0
    ds_write_b128 v234, v[208:211] offset:0
    ds_write_b128 v235, v[212:215] offset:0
    ds_write_b128 v236, v[216:219] offset:0
    ds_write_b128 v237, v[220:223] offset:0
    s_nop 0
    v_perm_b32 v192, v164, v160, s58
    v_perm_b32 v193, v172, v168, s58
    v_perm_b32 v194, v180, v176, s58
    v_perm_b32 v195, v188, v184, s58
    v_perm_b32 v196, v164, v160, s59
    v_perm_b32 v197, v172, v168, s59
    v_perm_b32 v198, v180, v176, s59
    v_perm_b32 v199, v188, v184, s59
    v_perm_b32 v200, v165, v161, s58
    v_perm_b32 v201, v173, v169, s58
    v_perm_b32 v202, v181, v177, s58
    v_perm_b32 v203, v189, v185, s58
    v_perm_b32 v204, v165, v161, s59
    v_perm_b32 v205, v173, v169, s59
    v_perm_b32 v206, v181, v177, s59
    v_perm_b32 v207, v189, v185, s59
    v_perm_b32 v208, v166, v162, s58
    v_perm_b32 v209, v174, v170, s58
    v_perm_b32 v210, v182, v178, s58
    v_perm_b32 v211, v190, v186, s58
    v_perm_b32 v212, v166, v162, s59
    v_perm_b32 v213, v174, v170, s59
    v_perm_b32 v214, v182, v178, s59
    v_perm_b32 v215, v190, v186, s59
    v_perm_b32 v216, v167, v163, s58
    v_perm_b32 v217, v175, v171, s58
    v_perm_b32 v218, v183, v179, s58
    v_perm_b32 v219, v191, v187, s58
    v_perm_b32 v220, v167, v163, s59
    v_perm_b32 v221, v175, v171, s59
    v_perm_b32 v222, v183, v179, s59
    v_perm_b32 v223, v191, v187, s59
    ds_write_b128 v230, v[192:195] offset:2048
    ds_write_b128 v231, v[196:199] offset:2048
    ds_write_b128 v232, v[200:203] offset:2048
    ds_write_b128 v233, v[204:207] offset:2048
    ds_write_b128 v234, v[208:211] offset:2048
    ds_write_b128 v235, v[212:215] offset:2048
    ds_write_b128 v236, v[216:219] offset:2048
    ds_write_b128 v237, v[220:223] offset:2048
    s_branch P1_DONE
P1_H:
    s_sub_u32 s20, s91, 192
    s_mov_b32 s8, s64
    s_mov_b32 s9, s65
    s_mov_b32 s10, 0x200000
    s_mov_b32 s11, 0x20000
    v_and_b32 v4, 31, v2
    v_lshrrev_b32 v5, 5, v2
    v_lshlrev_b32 v6, 10, v4
    v_lshl_add_u32 v6, v5, 4, v6
    s_lshl_b32 s21, s89, 7
    s_lshl_b32 s22, s20, 15
    s_add_u32 s21, s21, s22
    buffer_load_dwordx4 v[8:11], v6, s[8:11], s21 offen offset:0
    buffer_load_dwordx4 v[12:15], v6, s[8:11], s21 offen offset:32
    buffer_load_dwordx4 v[16:19], v6, s[8:11], s21 offen offset:64
    buffer_load_dwordx4 v[20:23], v6, s[8:11], s21 offen offset:96
    v_mov_b32 v30, 0
    global_load_dword v31, v30, s[84:85] sc1
    v_mov_b32 v24, 0
    v_mov_b32 v25, 0
    v_mov_b32 v26, 0
    v_mov_b32 v27, 0
    v_lshlrev_b32 v28, 3, v0
    v_lshlrev_b32 v29, 3, v4
    s_add_u32 s8, s86, 0x10000
    s_addc_u32 s9, s87, 0
    s_mov_b32 s10, 0x8000
    s_mov_b32 s11, 0x20000
    s_waitcnt vmcnt(4)
    v_lshlrev_b32 v32, 16, v8
    v_and_b32 v33, 0xffff0000, v8
    v_lshlrev_b32 v34, 16, v9
    v_and_b32 v35, 0xffff0000, v9
    v_lshlrev_b32 v36, 16, v10
    v_and_b32 v37, 0xffff0000, v10
    v_lshlrev_b32 v38, 16, v11
    v_and_b32 v39, 0xffff0000, v11
    v_add_f32 v24, v24, v32
    v_add_f32 v25, v25, v33
    v_fmac_f32 v26, v32, v32
    v_fmac_f32 v27, v33, v33
    v_add_f32 v24, v24, v34
    v_add_f32 v25, v25, v35
    v_fmac_f32 v26, v34, v34
    v_fmac_f32 v27, v35, v35
    v_add_f32 v24, v24, v36
    v_add_f32 v25, v25, v37
    v_fmac_f32 v26, v36, v36
    v_fmac_f32 v27, v37, v37
    v_add_f32 v24, v24, v38
    v_add_f32 v25, v25, v39
    v_fmac_f32 v26, v38, v38
    v_fmac_f32 v27, v39, v39
    s_waitcnt vmcnt(3)
    v_lshlrev_b32 v40, 16, v12
    v_and_b32 v41, 0xffff0000, v12
    v_lshlrev_b32 v42, 16, v13
    v_and_b32 v43, 0xffff0000, v13
    v_lshlrev_b32 v44, 16, v14
    v_and_b32 v45, 0xffff0000, v14
    v_lshlrev_b32 v46, 16, v15
    v_and_b32 v47, 0xffff0000, v15
    v_add_f32 v24, v24, v40
    v_add_f32 v25, v25, v41
    v_fmac_f32 v26, v40, v40
    v_fmac_f32 v27, v41, v41
    v_add_f32 v24, v24, v42
    v_add_f32 v25, v25, v43
    v_fmac_f32 v26, v42, v42
    v_fmac_f32 v27, v43, v43
    v_add_f32 v24, v24, v44
    v_add_f32 v25, v25, v45
    v_fmac_f32 v26, v44, v44
    v_fmac_f32 v27, v45, v45
    v_add_f32 v24, v24, v46
    v_add_f32 v25, v25, v47
    v_fmac_f32 v26, v46, v46
    v_fmac_f32 v27, v47, v47
    s_waitcnt vmcnt(2)
    v_lshlrev_b32 v48, 16, v16
    v_and_b32 v49, 0xffff0000, v16
    v_lshlrev_b32 v50, 16, v17
    v_and_b32 v51, 0xffff0000, v17
    v_lshlrev_b32 v52, 16, v18
    v_and_b32 v53, 0xffff0000, v18
    v_lshlrev_b32 v54, 16, v19
    v_and_b32 v55, 0xffff0000, v19
    v_add_f32 v24, v24, v48
    v_add_f32 v25, v25, v49
    v_fmac_f32 v26, v48, v48
    v_fmac_f32 v27, v49, v49
    v_add_f32 v24, v24, v50
    v_add_f32 v25, v25, v51
    v_fmac_f32 v26, v50, v50
    v_fmac_f32 v27, v51, v51
    v_add_f32 v24, v24, v52
    v_add_f32 v25, v25, v53
    v_fmac_f32 v26, v52, v52
    v_fmac_f32 v27, v53, v53
    v_add_f32 v24, v24, v54
    v_add_f32 v25, v25, v55
    v_fmac_f32 v26, v54, v54
    v_fmac_f32 v27, v55, v55
    s_waitcnt vmcnt(1)
    v_lshlrev_b32 v56, 16, v20
    v_and_b32 v57, 0xffff0000, v20
    v_lshlrev_b32 v58, 16, v21
    v_and_b32 v59, 0xffff0000, v21
    v_lshlrev_b32 v60, 16, v22
    v_and_b32 v61, 0xffff0000, v22
    v_lshlrev_b32 v62, 16, v23
    v_and_b32 v63, 0xffff0000, v23
    v_add_f32 v24, v24, v56
    v_add_f32 v25, v25, v57
    v_fmac_f32 v26, v56, v56
    v_fmac_f32 v27, v57, v57
    v_add_f32 v24, v24, v58
    v_add_f32 v25, v25, v59
    v_fmac_f32 v26, v58, v58
    v_fmac_f32 v27, v59, v59
    v_add_f32 v24, v24, v60
    v_add_f32 v25, v25, v61
    v_fmac_f32 v26, v60, v60
    v_fmac_f32 v27, v61, v61
    v_add_f32 v24, v24, v62
    v_add_f32 v25, v25, v63
    v_fmac_f32 v26, v62, v62
    v_fmac_f32 v27, v63, v63
    v_add_f32 v24, v24, v25
    v_add_f32 v25, v26, v27
    ds_write_b64 v28, v[24:25]
    s_waitcnt vmcnt(0)
    v_readfirstlane_b32 s22, v31
    s_mov_b32 s24, 0
    buffer_load_dwordx2 v[96:97], v28, s[8:11], s24 offen sc1
    s_mov_b32 s24, 8192
    buffer_load_dwordx2 v[98:99], v28, s[8:11], s24 offen sc1
    s_mov_b32 s24, 16384
    buffer_load_dwordx2 v[100:101], v28, s[8:11], s24 offen sc1
    s_mov_b32 s24, 24576
    buffer_load_dwordx2 v[102:103], v28, s[8:11], s24 offen sc1
    s_mov_b32 s24, 4096
    buffer_load_dwordx2 v[104:105], v28, s[8:11], s24 offen sc1
    s_mov_b32 s24, 12288
    buffer_load_dwordx2 v[106:107], v28, s[8:11], s24 offen sc1
    s_mov_b32 s24, 20480
    buffer_load_dwordx2 v[108:109], v28, s[8:11], s24 offen sc1
    s_mov_b32 s24, 28672
    buffer_load_dwordx2 v[110:111], v28, s[8:11], s24 offen sc1
    global_load_dword v31, v30, s[84:85] sc1
    s_waitcnt lgkmcnt(0)
    s_barrier
    ds_read_b64 v[64:65], v29 offset:0
    ds_read_b64 v[66:67], v29 offset:256
    ds_read_b64 v[68:69], v29 offset:512
    ds_read_b64 v[70:71], v29 offset:768
    ds_read_b64 v[72:73], v29 offset:1024
    ds_read_b64 v[74:75], v29 offset:1280
    ds_read_b64 v[76:77], v29 offset:1536
    ds_read_b64 v[78:79], v29 offset:1792
    ds_read_b64 v[80:81], v29 offset:2048
    ds_read_b64 v[82:83], v29 offset:2304
    ds_read_b64 v[84:85], v29 offset:2560
    ds_read_b64 v[86:87], v29 offset:2816
    ds_read_b64 v[88:89], v29 offset:3072
    ds_read_b64 v[90:91], v29 offset:3328
    ds_read_b64 v[92:93], v29 offset:3584
    ds_read_b64 v[94:95], v29 offset:3840
    s_waitcnt lgkmcnt(0)
    v_add_f32 v64, v64, v80
    v_add_f32 v65, v65, v81
    v_add_f32 v66, v66, v82
    v_add_f32 v67, v67, v83
    v_add_f32 v68, v68, v84
    v_add_f32 v69, v69, v85
    v_add_f32 v70, v70, v86
    v_add_f32 v71, v71, v87
    v_add_f32 v72, v72, v88
    v_add_f32 v73, v73, v89
    v_add_f32 v74, v74, v90
    v_add_f32 v75, v75, v91
    v_add_f32 v76, v76, v92
    v_add_f32 v77, v77, v93
    v_add_f32 v78, v78, v94
    v_add_f32 v79, v79, v95
    v_add_f32 v64, v64, v72
    v_add_f32 v65, v65, v73
    v_add_f32 v66, v66, v74
    v_add_f32 v67, v67, v75
    v_add_f32 v68, v68, v76
    v_add_f32 v69, v69, v77
    v_add_f32 v70, v70, v78
    v_add_f32 v71, v71, v79
    v_add_f32 v64, v64, v68
    v_add_f32 v65, v65, v69
    v_add_f32 v66, v66, v70
    v_add_f32 v67, v67, v71
    v_add_f32 v64, v64, v66
    v_add_f32 v65, v65, v67
    v_mul_f32 v24, 0x3b000000, v64
    v_mul_f32 v25, 0x3b000000, v65
    v_fma_f32 v25, -v24, v24, v25
    v_max_f32 v25, 0, v25
    v_add_f32 v25, 0x3727c5ac, v25
    v_rsq_f32 v25, v25
    s_nop 0
    v_mul_f32 v24, v24, v25
    v_sub_f32 v24, 0, v24
    v_fma_f32 v32, v32, v25, v24
    v_fma_f32 v33, v33, v25, v24
    v_fma_f32 v34, v34, v25, v24
    v_fma_f32 v35, v35, v25, v24
    v_fma_f32 v36, v36, v25, v24
    v_fma_f32 v37, v37, v25, v24
    v_fma_f32 v38, v38, v25, v24
    v_fma_f32 v39, v39, v25, v24
    v_fma_f32 v40, v40, v25, v24
    v_fma_f32 v41, v41, v25, v24
    v_fma_f32 v42, v42, v25, v24
    v_fma_f32 v43, v43, v25, v24
    v_fma_f32 v44, v44, v25, v24
    v_fma_f32 v45, v45, v25, v24
    v_fma_f32 v46, v46, v25, v24
    v_fma_f32 v47, v47, v25, v24
    v_fma_f32 v48, v48, v25, v24
    v_fma_f32 v49, v49, v25, v24
    v_fma_f32 v50, v50, v25, v24
    v_fma_f32 v51, v51, v25, v24
    v_fma_f32 v52, v52, v25, v24
    v_fma_f32 v53, v53, v25, v24
    v_fma_f32 v54, v54, v25, v24
    v_fma_f32 v55, v55, v25, v24
    v_fma_f32 v56, v56, v25, v24
    v_fma_f32 v57, v57, v25, v24
    v_fma_f32 v58, v58, v25, v24
    v_fma_f32 v59, v59, v25, v24
    v_fma_f32 v60, v60, v25, v24
    v_fma_f32 v61, v61, v25, v24
    v_fma_f32 v62, v62, v25, v24
    v_fma_f32 v63, v63, v25, v24
    s_mov_b32 s23, 0
    s_branch P1_HCHK
P1_HPOLL:
    s_waitcnt vmcnt(0)
    v_readfirstlane_b32 s22, v31
    s_mov_b32 s24, 0
    buffer_load_dwordx2 v[96:97], v28, s[8:11], s24 offen sc1
    s_mov_b32 s24, 8192
    buffer_load_dwordx2 v[98:99], v28, s[8:11], s24 offen sc1
    s_mov_b32 s24, 16384
    buffer_load_dwordx2 v[100:101], v28, s[8:11], s24 offen sc1
    s_mov_b32 s24, 24576
    buffer_load_dwordx2 v[102:103], v28, s[8:11], s24 offen sc1
    s_mov_b32 s24, 4096
    buffer_load_dwordx2 v[104:105], v28, s[8:11], s24 offen sc1
    s_mov_b32 s24, 12288
    buffer_load_dwordx2 v[106:107], v28, s[8:11], s24 offen sc1
    s_mov_b32 s24, 20480
    buffer_load_dwordx2 v[108:109], v28, s[8:11], s24 offen sc1
    s_mov_b32 s24, 28672
    buffer_load_dwordx2 v[110:111], v28, s[8:11], s24 offen sc1
    global_load_dword v31, v30, s[84:85] sc1
P1_HCHK:
    s_add_u32 s23, s23, 1
    s_cmp_gt_u32 s23, 0x4000
    s_cbranch_scc1 P1_HGOT
    s_cmp_eq_u32 s22, 0
    s_cbranch_scc1 P1_HPOLL
    s_waitcnt vmcnt(1)
    v_xor_b32 v26, s22, v97
    v_xor_b32 v81, s22, v99
    v_xor_b32 v82, s22, v101
    v_xor_b32 v83, s22, v103
    v_xor_b32 v84, s22, v105
    v_xor_b32 v85, s22, v107
    v_xor_b32 v86, s22, v109
    v_xor_b32 v87, s22, v111
    v_or3_b32 v26, v26, v81, v82
    v_or3_b32 v26, v26, v83, v84
    v_or3_b32 v26, v26, v85, v86
    v_or_b32 v26, v26, v87
    v_cmp_ne_u32 vcc, 0, v26
    s_nop 1
    s_cmp_lg_u64 vcc, 0
    s_cbranch_scc1 P1_HPOLL
P1_HGOT:
    s_mov_b32 s88, s22
    v_add_f32 v96, v96, v98
    v_add_f32 v100, v100, v102
    v_add_f32 v104, v104, v106
    v_add_f32 v108, v108, v110
    v_add_f32 v96, v96, v100
    v_add_f32 v104, v104, v108
    v_cvt_pk_bf16_f32 v64, v96, v104
    v_lshlrev_b32 v65, 16, v64
    v_and_b32 v66, 0xffff0000, v64
    v_add_f32 v66, 1.0, v66
    v_cvt_pk_bf16_f32 v66, v66, v66
    v_lshlrev_b32 v66, 16, v66
    v_lshlrev_b32 v28, 2, v0
    ds_write_b32 v28, v65 offset:4096
    ds_write_b32 v28, v66 offset:6144
    s_lshl_b32 s22, s89, 8
    v_lshlrev_b32 v28, 5, v5
    v_add_u32 v28, s22, v28
    s_add_u32 s8, s86, 0x100000
    s_addc_u32 s9, s87, 0
    s_mov_b32 s10, 0x200000
    s_mov_b32 s11, 0x20000
    s_lshl_b32 s21, s89, 12
    s_lshl_b32 s22, s20, 15
    s_add_u32 s21, s21, s22
    s_waitcnt lgkmcnt(0)
    s_barrier
    ds_read_b128 v[64:67], v28 offset:4096
    ds_read_b128 v[68:71], v28 offset:4112
    ds_read_b128 v[96:99], v28 offset:6144
    ds_read_b128 v[100:103], v28 offset:6160
    ds_read_b128 v[72:75], v28 offset:4160
    ds_read_b128 v[76:79], v28 offset:4176
    ds_read_b128 v[104:107], v28 offset:6208
    ds_read_b128 v[108:111], v28 offset:6224
    ds_read_b128 v[80:83], v28 offset:4224
    ds_read_b128 v[84:87], v28 offset:4240
    ds_read_b128 v[112:115], v28 offset:6272
    ds_read_b128 v[116:119], v28 offset:6288
    ds_read_b128 v[88:91], v28 offset:4288
    ds_read_b128 v[92:95], v28 offset:4304
    ds_read_b128 v[120:123], v28 offset:6336
    ds_read_b128 v[124:127], v28 offset:6352
    s_waitcnt lgkmcnt(12)
    v_fma_f32 v32, v32, v96, v64
    v_fma_f32 v33, v33, v97, v65
    v_fma_f32 v34, v34, v98, v66
    v_fma_f32 v35, v35, v99, v67
    v_fma_f32 v36, v36, v100, v68
    v_fma_f32 v37, v37, v101, v69
    v_fma_f32 v38, v38, v102, v70
    v_fma_f32 v39, v39, v103, v71
    v_cvt_pk_bf16_f32 v8, v32, v33
    v_cvt_pk_bf16_f32 v9, v34, v35
    v_cvt_pk_bf16_f32 v10, v36, v37
    v_cvt_pk_bf16_f32 v11, v38, v39
    buffer_store_dwordx4 v[8:11], v3, s[8:11], s21 offen offset:0 sc1
    s_waitcnt lgkmcnt(8)
    v_fma_f32 v40, v40, v104, v72
    v_fma_f32 v41, v41, v105, v73
    v_fma_f32 v42, v42, v106, v74
    v_fma_f32 v43, v43, v107, v75
    v_fma_f32 v44, v44, v108, v76
    v_fma_f32 v45, v45, v109, v77
    v_fma_f32 v46, v46, v110, v78
    v_fma_f32 v47, v47, v111, v79
    v_cvt_pk_bf16_f32 v12, v40, v41
    v_cvt_pk_bf16_f32 v13, v42, v43
    v_cvt_pk_bf16_f32 v14, v44, v45
    v_cvt_pk_bf16_f32 v15, v46, v47
    buffer_store_dwordx4 v[12:15], v3, s[8:11], s21 offen offset:1024 sc1
    s_waitcnt lgkmcnt(4)
    v_fma_f32 v48, v48, v112, v80
    v_fma_f32 v49, v49, v113, v81
    v_fma_f32 v50, v50, v114, v82
    v_fma_f32 v51, v51, v115, v83
    v_fma_f32 v52, v52, v116, v84
    v_fma_f32 v53, v53, v117, v85
    v_fma_f32 v54, v54, v118, v86
    v_fma_f32 v55, v55, v119, v87
    v_cvt_pk_bf16_f32 v16, v48, v49
    v_cvt_pk_bf16_f32 v17, v50, v51
    v_cvt_pk_bf16_f32 v18, v52, v53
    v_cvt_pk_bf16_f32 v19, v54, v55
    buffer_store_dwordx4 v[16:19], v3, s[8:11], s21 offen offset:2048 sc1
    s_waitcnt lgkmcnt(0)
    v_fma_f32 v56, v56, v120, v88
    v_fma_f32 v57, v57, v121, v89
    v_fma_f32 v58, v58, v122, v90
    v_fma_f32 v59, v59, v123, v91
    v_fma_f32 v60, v60, v124, v92
    v_fma_f32 v61, v61, v125, v93
    v_fma_f32 v62, v62, v126, v94
    v_fma_f32 v63, v63, v127, v95
    v_cvt_pk_bf16_f32 v20, v56, v57
    v_cvt_pk_bf16_f32 v21, v58, v59
    v_cvt_pk_bf16_f32 v22, v60, v61
    v_cvt_pk_bf16_f32 v23, v62, v63
    buffer_store_dwordx4 v[20:23], v3, s[8:11], s21 offen offset:3072 sc1
    s_add_u32 s22, s20, 192
    s_waitcnt vmcnt(0) lgkmcnt(0)
    s_barrier
    s_cmp_eq_u32 s89, 0
    s_cbranch_scc0 PUB_7
    s_cmp_lg_u32 s88, 0
    s_cbranch_scc1 NONCE_8_OK
    s_waitcnt vmcnt(0)
    v_readfirstlane_b32 s88, v249
    s_nop 1
    s_cmp_lg_u32 s88, 0
    s_cbranch_scc1 NONCE_8_OK
    s_mov_b32 s98, 0
NONCE_8_L:
    v_mov_b32 v250, 0
    global_load_dword v251, v250, s[84:85] sc1
    s_waitcnt vmcnt(0)
    v_readfirstlane_b32 s88, v251
    s_add_u32 s98, s98, 1
    s_cmp_gt_u32 s98, 0x4000
    s_cbranch_scc1 NONCE_8_OK
    s_cmp_eq_u32 s88, 0
    s_cbranch_scc1 NONCE_8_L
NONCE_8_OK:
    s_lshl_b32 s98, s22, 7
    v_mov_b32 v250, s98
    v_mov_b32 v251, s88
    s_mov_b64 exec, 1
    buffer_store_dword v251, v250, s[92:95], 0 offen sc1
    s_mov_b64 exec, -1
PUB_7:
    s_sub_u32 s40, s91, 192
    s_mul_i32 s40, s40, 6
    s_add_u32 s40, s40, s89
    s_cmp_ge_u32 s89, 6
    s_cselect_b32 s40, 1000, s40
    s_min_u32 s40, s40, 352
    s_and_b32 s43, s40, 1
    s_bfe_u32 s44, s40, 0x30001
    s_lshr_b32 s41, s40, 4
    s_cmp_eq_u32 s43, 0
    s_cselect_b32 s52, s72, s74
    s_cselect_b32 s53, s73, s75
    s_mov_b32 s54, 1409024
    s_mov_b32 s55, 0x20000
    v_and_b32 v224, 7, v2
    v_bfe_u32 v225, v2, 3, 1
    v_lshrrev_b32 v226, 4, v2
    v_lshlrev_b32 v227, 4, v226
    v_lshl_add_u32 v227, v225, 2, v227
    v_mul_u32_u24 v228, 2752, v227
    v_lshl_add_u32 v228, v224, 4, v228
    s_lshl_b32 s45, s44, 6
    s_mul_i32 s46, s45, 2752
    s_lshl_b32 s47, s41, 7
    s_add_u32 s46, s46, s47
    buffer_load_dwordx4 v[192:195], v228, s[52:55], s46 offen
    s_add_u32 s46, s46, 2752
    buffer_load_dwordx4 v[196:199], v228, s[52:55], s46 offen
    s_add_u32 s46, s46, 2752
    buffer_load_dwordx4 v[200:203], v228, s[52:55], s46 offen
    s_add_u32 s46, s46, 2752
    buffer_load_dwordx4 v[204:207], v228, s[52:55], s46 offen
    s_add_u32 s46, s46, 13760
    buffer_load_dwordx4 v[208:211], v228, s[52:55], s46 offen
    s_add_u32 s46, s46, 2752
    buffer_load_dwordx4 v[212:215], v228, s[52:55], s46 offen
    s_add_u32 s46, s46, 2752
    buffer_load_dwordx4 v[216:219], v228, s[52:55], s46 offen
    s_add_u32 s46, s46, 2752
    buffer_load_dwordx4 v[220:223], v228, s[52:55], s46 offen
P1_DONE:
    s_cmp_ge_u32 s91, 192
    s_cbranch_scc1 P2_UP
    v_mov_b32 v4, 24576
    v_mov_b32 v5, 0
    ds_write_b32 v4, v5
    ds_write_b32 v4, v5 offset:8
    s_add_u32 s8, s86, 0x100000
    s_addc_u32 s9, s87, 0
    s_mov_b32 s10, 0x200000
    s_mov_b32 s11, 0x20000
    s_add_u32 s28, s86, 0x500000
    s_addc_u32 s29, s87, 0
    s_mov_b32 s30, 0x600000
    s_mov_b32 s31, 0x20000
    s_cmp_eq_u32 s89, 0
    s_cbranch_scc0 WAIT_9_B
    s_cmp_lg_u32 s88, 0
    s_cbranch_scc1 NONCE_10_OK
    s_waitcnt vmcnt(0)
    v_readfirstlane_b32 s88, v249
    s_nop 1
    s_cmp_lg_u32 s88, 0
    s_cbranch_scc1 NONCE_10_OK
    s_mov_b32 s98, 0
NONCE_10_L:
    v_mov_b32 v250, 0
    global_load_dword v251, v250, s[84:85] sc1
    s_waitcnt vmcnt(0)
    v_readfirstlane_b32 s88, v251
    s_add_u32 s98, s98, 1
    s_cmp_gt_u32 s98, 0x4000
    s_cbranch_scc1 NONCE_10_OK
    s_cmp_eq_u32 s88, 0
    s_cbranch_scc1 NONCE_10_L
NONCE_10_OK:
    s_lshl_b32 s98, s56, 2
    s_add_u32 s98, s98, 192
    v_and_b32 v250, 3, v2
    v_add_u32 v250, s98, v250
    v_lshlrev_b32 v250, 7, v250
    s_mov_b32 s98, 0
    buffer_load_dword v251, v250, s[92:95], 0 offen sc1
WAIT_9_L:
    buffer_load_dword v254, v250, s[92:95], 0 offen sc1
    s_waitcnt vmcnt(1)
    v_cmp_ne_u32 vcc, s88, v251
    s_nop 1
    s_cmp_eq_u64 vcc, 0
    s_cbranch_scc1 WAIT_9_E
    buffer_load_dword v251, v250, s[92:95], 0 offen sc1
    s_add_u32 s98, s98, 1
    s_waitcnt vmcnt(1)
    v_cmp_ne_u32 vcc, s88, v254
    s_nop 1
    s_cmp_eq_u64 vcc, 0
    s_cbranch_scc1 WAIT_9_E
    s_cmp_gt_u32 s98, 0x2000
    s_cbranch_scc0 WAIT_9_L
WAIT_9_E:
    v_mov_b32 v252, 24580
    v_mov_b32 v253, s88
    ds_write_b32 v252, v253
    s_waitcnt lgkmcnt(0)
WAIT_9_B:
    s_waitcnt lgkmcnt(0)
    s_barrier
    v_mov_b32 v252, 24580
    ds_read_b32 v253, v252
    s_waitcnt lgkmcnt(0)
    v_readfirstlane_b32 s88, v253
    s_cmp_ge_u32 s89, 4
    s_cbranch_scc1 P2_HELP
    s_lshl_b32 s20, s56, 2
    s_add_u32 s23, s20, s89
    s_lshl_b32 s24, s23, 15
    v_bfe_u32 v4, v2, 3, 2
    v_xor_b32 v4, v4, v2
    v_xor_b32 v8, 0, v4
    v_lshlrev_b32 v8, 4, v8
    v_add_u32 v8, 32768, v8
    v_add_u32 v12, 0x10000, v8
    v_xor_b32 v9, 4, v4
    v_lshlrev_b32 v9, 4, v9
    v_add_u32 v9, 32768, v9
    v_add_u32 v13, 0x10000, v9
    s_cmp_ge_u32 s57, 8
    s_cbranch_scc1 P2_V
    s_mov_b32 s25, s24
    buffer_load_dwordx4 v[48:51], v3, s[8:11], s25 offen offset:0 sc1
    buffer_load_dwordx4 v[52:55], v3, s[8:11], s25 offen offset:1024 sc1
    buffer_load_dwordx4 v[56:59], v3, s[8:11], s25 offen offset:2048 sc1
    buffer_load_dwordx4 v[60:63], v3, s[8:11], s25 offen offset:3072 sc1
    s_add_u32 s25, s25, 4096
    buffer_load_dwordx4 v[64:67], v3, s[8:11], s25 offen offset:0 sc1
    buffer_load_dwordx4 v[68:71], v3, s[8:11], s25 offen offset:1024 sc1
    ds_read_b128 v[16:19], v8 offset:0
    ds_read_b128 v[20:23], v9 offset:1024
    ds_read_b128 v[24:27], v8 offset:2048
    ds_read_b128 v[28:31], v9 offset:3072
    s_waitcnt vmcnt(5)
    s_waitcnt lgkmcnt(3)
    v_mfma_f32_32x32x16_bf16 v[136:151], v[16:19], v[48:51], 0
    ds_read_b128 v[32:35], v8 offset:4096
    s_waitcnt lgkmcnt(3)
    v_mfma_f32_32x32x16_bf16 v[152:167], v[20:23], v[48:51], 0
    ds_read_b128 v[36:39], v9 offset:5120
    buffer_load_dwordx4 v[72:75], v3, s[8:11], s25 offen offset:2048 sc1
    s_waitcnt lgkmcnt(3)
    v_mfma_f32_32x32x16_bf16 v[168:183], v[24:27], v[48:51], 0
    ds_read_b128 v[40:43], v8 offset:6144
    s_waitcnt lgkmcnt(3)
    v_mfma_f32_32x32x16_bf16 v[184:199], v[28:31], v[48:51], 0
    ds_read_b128 v[44:47], v9 offset:7168
    buffer_load_dwordx4 v[76:79], v3, s[8:11], s25 offen offset:3072 sc1
    s_add_u32 s25, s25, 4096
    s_waitcnt vmcnt(6)
    s_waitcnt lgkmcnt(3)
    v_mfma_f32_32x32x16_bf16 v[136:151], v[32:35], v[52:55], v[136:151]
    ds_read_b128 v[16:19], v8 offset:8192
    s_waitcnt lgkmcnt(3)
    v_mfma_f32_32x32x16_bf16 v[152:167], v[36:39], v[52:55], v[152:167]
    ds_read_b128 v[20:23], v9 offset:9216
    buffer_load_dwordx4 v[80:83], v3, s[8:11], s25 offen offset:0 sc1
    s_waitcnt lgkmcnt(3)
    v_mfma_f32_32x32x16_bf16 v[168:183], v[40:43], v[52:55], v[168:183]
    ds_read_b128 v[24:27], v8 offset:10240
    s_waitcnt lgkmcnt(3)
    v_mfma_f32_32x32x16_bf16 v[184:199], v[44:47], v[52:55], v[184:199]
    ds_read_b128 v[28:31], v9 offset:11264
    buffer_load_dwordx4 v[84:87], v3, s[8:11], s25 offen offset:1024 sc1
    s_waitcnt vmcnt(7)
    s_waitcnt lgkmcnt(3)
    v_mfma_f32_32x32x16_bf16 v[136:151], v[16:19], v[56:59], v[136:151]
    ds_read_b128 v[32:35], v8 offset:12288
    s_waitcnt lgkmcnt(3)
    v_mfma_f32_32x32x16_bf16 v[152:167], v[20:23], v[56:59], v[152:167]
    ds_read_b128 v[36:39], v9 offset:13312
    buffer_load_dwordx4 v[88:91], v3, s[8:11], s25 offen offset:2048 sc1
    s_waitcnt lgkmcnt(3)
    v_mfma_f32_32x32x16_bf16 v[168:183], v[24:27], v[56:59], v[168:183]
    ds_read_b128 v[40:43], v8 offset:14336
    s_waitcnt lgkmcnt(3)
    v_mfma_f32_32x32x16_bf16 v[184:199], v[28:31], v[56:59], v[184:199]
    ds_read_b128 v[44:47], v9 offset:15360
    buffer_load_dwordx4 v[92:95], v3, s[8:11], s25 offen offset:3072 sc1
    s_add_u32 s25, s25, 4096
    s_waitcnt vmcnt(8)
    s_waitcnt lgkmcnt(3)
    v_mfma_f32_32x32x16_bf16 v[136:151], v[32:35], v[60:63], v[136:151]
    ds_read_b128 v[16:19], v8 offset:16384
    s_waitcnt lgkmcnt(3)
    v_mfma_f32_32x32x16_bf16 v[152:167], v[36:39], v[60:63], v[152:167]
    ds_read_b128 v[20:23], v9 offset:17408
    buffer_load_dwordx4 v[96:99], v3, s[8:11], s25 offen offset:0 sc1
    s_waitcnt lgkmcnt(3)
    v_mfma_f32_32x32x16_bf16 v[168:183], v[40:43], v[60:63], v[168:183]
    ds_read_b128 v[24:27], v8 offset:18432
    s_waitcnt lgkmcnt(3)
    v_mfma_f32_32x32x16_bf16 v[184:199], v[44:47], v[60:63], v[184:199]
    ds_read_b128 v[28:31], v9 offset:19456
    buffer_load_dwordx4 v[100:103], v3, s[8:11], s25 offen offset:1024 sc1
    s_waitcnt vmcnt(9)
    s_waitcnt lgkmcnt(3)
    v_mfma_f32_32x32x16_bf16 v[136:151], v[16:19], v[64:67], v[136:151]
    ds_read_b128 v[32:35], v8 offset:20480
    s_waitcnt lgkmcnt(3)
    v_mfma_f32_32x32x16_bf16 v[152:167], v[20:23], v[64:67], v[152:167]
    ds_read_b128 v[36:39], v9 offset:21504
    buffer_load_dwordx4 v[104:107], v3, s[8:11], s25 offen offset:2048 sc1
    s_waitcnt lgkmcnt(3)
    v_mfma_f32_32x32x16_bf16 v[168:183], v[24:27], v[64:67], v[168:183]
    ds_read_b128 v[40:43], v8 offset:22528
    s_waitcnt lgkmcnt(3)
    v_mfma_f32_32x32x16_bf16 v[184:199], v[28:31], v[64:67], v[184:199]
    ds_read_b128 v[44:47], v9 offset:23552
    buffer_load_dwordx4 v[108:111], v3, s[8:11], s25 offen offset:3072 sc1
    s_add_u32 s25, s25, 4096
    s_waitcnt vmcnt(10)
    s_waitcnt lgkmcnt(3)
    v_mfma_f32_32x32x16_bf16 v[136:151], v[32:35], v[68:71], v[136:151]
    ds_read_b128 v[16:19], v8 offset:24576
    s_waitcnt lgkmcnt(3)
    v_mfma_f32_32x32x16_bf16 v[152:167], v[36:39], v[68:71], v[152:167]
    ds_read_b128 v[20:23], v9 offset:25600
    buffer_load_dwordx4 v[112:115], v3, s[8:11], s25 offen offset:0 sc1
    s_waitcnt lgkmcnt(3)
    v_mfma_f32_32x32x16_bf16 v[168:183], v[40:43], v[68:71], v[168:183]
    ds_read_b128 v[24:27], v8 offset:26624
    s_waitcnt lgkmcnt(3)
    v_mfma_f32_32x32x16_bf16 v[184:199], v[44:47], v[68:71], v[184:199]
    ds_read_b128 v[28:31], v9 offset:27648
    buffer_load_dwordx4 v[116:119], v3, s[8:11], s25 offen offset:1024 sc1
    s_waitcnt vmcnt(11)
    s_waitcnt lgkmcnt(3)
    v_mfma_f32_32x32x16_bf16 v[136:151], v[16:19], v[72:75], v[136:151]
    ds_read_b128 v[32:35], v8 offset:28672
    s_waitcnt lgkmcnt(3)
    v_mfma_f32_32x32x16_bf16 v[152:167], v[20:23], v[72:75], v[152:167]
    ds_read_b128 v[36:39], v9 offset:29696
    buffer_load_dwordx4 v[120:123], v3, s[8:11], s25 offen offset:2048 sc1
    s_waitcnt lgkmcnt(3)
    v_mfma_f32_32x32x16_bf16 v[168:183], v[24:27], v[72:75], v[168:183]
    ds_read_b128 v[40:43], v8 offset:30720
    s_waitcnt lgkmcnt(3)
    v_mfma_f32_32x32x16_bf16 v[184:199], v[28:31], v[72:75], v[184:199]
    ds_read_b128 v[44:47], v9 offset:31744
    buffer_load_dwordx4 v[124:127], v3, s[8:11], s25 offen offset:3072 sc1
    s_add_u32 s25, s25, 4096
    s_waitcnt vmcnt(12)
    s_waitcnt lgkmcnt(3)
    v_mfma_f32_32x32x16_bf16 v[136:151], v[32:35], v[76:79], v[136:151]
    ds_read_b128 v[16:19], v8 offset:32768
    s_waitcnt lgkmcnt(3)
    v_mfma_f32_32x32x16_bf16 v[152:167], v[36:39], v[76:79], v[152:167]
    ds_read_b128 v[20:23], v9 offset:33792
    buffer_load_dwordx4 v[128:131], v3, s[8:11], s25 offen offset:0 sc1
    s_waitcnt lgkmcnt(3)
    v_mfma_f32_32x32x16_bf16 v[168:183], v[40:43], v[76:79], v[168:183]
    ds_read_b128 v[24:27], v8 offset:34816
    s_waitcnt lgkmcnt(3)
    v_mfma_f32_32x32x16_bf16 v[184:199], v[44:47], v[76:79], v[184:199]
    ds_read_b128 v[28:31], v9 offset:35840
    buffer_load_dwordx4 v[132:135], v3, s[8:11], s25 offen offset:1024 sc1
    s_waitcnt vmcnt(13)
    s_waitcnt lgkmcnt(3)
    v_mfma_f32_32x32x16_bf16 v[136:151], v[16:19], v[80:83], v[136:151]
    ds_read_b128 v[32:35], v8 offset:36864
    s_waitcnt lgkmcnt(3)
    v_mfma_f32_32x32x16_bf16 v[152:167], v[20:23], v[80:83], v[152:167]
    ds_read_b128 v[36:39], v9 offset:37888
    buffer_load_dwordx4 v[48:51], v3, s[8:11], s25 offen offset:2048 sc1
    s_waitcnt lgkmcnt(3)
    v_mfma_f32_32x32x16_bf16 v[168:183], v[24:27], v[80:83], v[168:183]
    ds_read_b128 v[40:43], v8 offset:38912
    s_waitcnt lgkmcnt(3)
    v_mfma_f32_32x32x16_bf16 v[184:199], v[28:31], v[80:83], v[184:199]
    ds_read_b128 v[44:47], v9 offset:39936
    buffer_load_dwordx4 v[52:55], v3, s[8:11], s25 offen offset:3072 sc1
    s_add_u32 s25, s25, 4096
    s_waitcnt vmcnt(14)
    s_waitcnt lgkmcnt(3)
    v_mfma_f32_32x32x16_bf16 v[136:151], v[32:35], v[84:87], v[136:151]
    ds_read_b128 v[16:19], v8 offset:40960
    s_waitcnt lgkmcnt(3)
    v_mfma_f32_32x32x16_bf16 v[152:167], v[36:39], v[84:87], v[152:167]
    ds_read_b128 v[20:23], v9 offset:41984
    buffer_load_dwordx4 v[56:59], v3, s[8:11], s25 offen offset:0 sc1
    s_waitcnt lgkmcnt(3)
    v_mfma_f32_32x32x16_bf16 v[168:183], v[40:43], v[84:87], v[168:183]
    ds_read_b128 v[24:27], v8 offset:43008
    s_waitcnt lgkmcnt(3)
    v_mfma_f32_32x32x16_bf16 v[184:199], v[44:47], v[84:87], v[184:199]
    ds_read_b128 v[28:31], v9 offset:44032
    buffer_load_dwordx4 v[60:63], v3, s[8:11], s25 offen offset:1024 sc1
    s_waitcnt vmcnt(15)
    s_waitcnt lgkmcnt(3)
    v_mfma_f32_32x32x16_bf16 v[136:151], v[16:19], v[88:91], v[136:151]
    ds_read_b128 v[32:35], v8 offset:45056
    s_waitcnt lgkmcnt(3)
    v_mfma_f32_32x32x16_bf16 v[152:167], v[20:23], v[88:91], v[152:167]
    ds_read_b128 v[36:39], v9 offset:46080
    buffer_load_dwordx4 v[64:67], v3, s[8:11], s25 offen offset:2048 sc1
    s_waitcnt lgkmcnt(3)
    v_mfma_f32_32x32x16_bf16 v[168:183], v[24:27], v[88:91], v[168:183]
    ds_read_b128 v[40:43], v8 offset:47104
    s_waitcnt lgkmcnt(3)
    v_mfma_f32_32x32x16_bf16 v[184:199], v[28:31], v[88:91], v[184:199]
    ds_read_b128 v[44:47], v9 offset:48128
    buffer_load_dwordx4 v[68:71], v3, s[8:11], s25 offen offset:3072 sc1
    s_add_u32 s25, s25, 4096
    s_waitcnt vmcnt(16)
    s_waitcnt lgkmcnt(3)
    v_mfma_f32_32x32x16_bf16 v[136:151], v[32:35], v[92:95], v[136:151]
    ds_read_b128 v[16:19], v8 offset:49152
    s_waitcnt lgkmcnt(3)
    v_mfma_f32_32x32x16_bf16 v[152:167], v[36:39], v[92:95], v[152:167]
    ds_read_b128 v[20:23], v9 offset:50176
    buffer_load_dwordx4 v[72:75], v3, s[8:11], s25 offen offset:0 sc1
    s_waitcnt lgkmcnt(3)
    v_mfma_f32_32x32x16_bf16 v[168:183], v[40:43], v[92:95], v[168:183]
    ds_read_b128 v[24:27], v8 offset:51200
    s_waitcnt lgkmcnt(3)
    v_mfma_f32_32x32x16_bf16 v[184:199], v[44:47], v[92:95], v[184:199]
    ds_read_b128 v[28:31], v9 offset:52224
    buffer_load_dwordx4 v[76:79], v3, s[8:11], s25 offen offset:1024 sc1
    s_waitcnt vmcnt(17)
    s_waitcnt lgkmcnt(3)
    v_mfma_f32_32x32x16_bf16 v[136:151], v[16:19], v[96:99], v[136:151]
    ds_read_b128 v[32:35], v8 offset:53248
    s_waitcnt lgkmcnt(3)
    v_mfma_f32_32x32x16_bf16 v[152:167], v[20:23], v[96:99], v[152:167]
    ds_read_b128 v[36:39], v9 offset:54272
    buffer_load_dwordx4 v[80:83], v3, s[8:11], s25 offen offset:2048 sc1
    s_waitcnt lgkmcnt(3)
    v_mfma_f32_32x32x16_bf16 v[168:183], v[24:27], v[96:99], v[168:183]
    ds_read_b128 v[40:43], v8 offset:55296
    s_waitcnt lgkmcnt(3)
    v_mfma_f32_32x32x16_bf16 v[184:199], v[28:31], v[96:99], v[184:199]
    ds_read_b128 v[44:47], v9 offset:56320
    buffer_load_dwordx4 v[84:87], v3, s[8:11], s25 offen offset:3072 sc1
    s_add_u32 s25, s25, 4096
    s_waitcnt vmcnt(18)
    s_waitcnt lgkmcnt(3)
    v_mfma_f32_32x32x16_bf16 v[136:151], v[32:35], v[100:103], v[136:151]
    ds_read_b128 v[16:19], v8 offset:57344
    s_waitcnt lgkmcnt(3)
    v_mfma_f32_32x32x16_bf16 v[152:167], v[36:39], v[100:103], v[152:167]
    ds_read_b128 v[20:23], v9 offset:58368
    s_waitcnt lgkmcnt(3)
    v_mfma_f32_32x32x16_bf16 v[168:183], v[40:43], v[100:103], v[168:183]
    ds_read_b128 v[24:27], v8 offset:59392
    s_waitcnt lgkmcnt(3)
    v_mfma_f32_32x32x16_bf16 v[184:199], v[44:47], v[100:103], v[184:199]
    ds_read_b128 v[28:31], v9 offset:60416
    s_waitcnt vmcnt(17)
    s_waitcnt lgkmcnt(3)
    v_mfma_f32_32x32x16_bf16 v[136:151], v[16:19], v[104:107], v[136:151]
    ds_read_b128 v[32:35], v8 offset:61440
    s_waitcnt lgkmcnt(3)
    v_mfma_f32_32x32x16_bf16 v[152:167], v[20:23], v[104:107], v[152:167]
    ds_read_b128 v[36:39], v9 offset:62464
    s_waitcnt lgkmcnt(3)
    v_mfma_f32_32x32x16_bf16 v[168:183], v[24:27], v[104:107], v[168:183]
    ds_read_b128 v[40:43], v8 offset:63488
    s_waitcnt lgkmcnt(3)
    v_mfma_f32_32x32x16_bf16 v[184:199], v[28:31], v[104:107], v[184:199]
    ds_read_b128 v[44:47], v9 offset:64512
    s_waitcnt vmcnt(16)
    s_waitcnt lgkmcnt(3)
    v_mfma_f32_32x32x16_bf16 v[136:151], v[32:35], v[108:111], v[136:151]
    ds_read_b128 v[16:19], v12 offset:0
    s_waitcnt lgkmcnt(3)
    v_mfma_f32_32x32x16_bf16 v[152:167], v[36:39], v[108:111], v[152:167]
    ds_read_b128 v[20:23], v13 offset:1024
    s_waitcnt lgkmcnt(3)
    v_mfma_f32_32x32x16_bf16 v[168:183], v[40:43], v[108:111], v[168:183]
    ds_read_b128 v[24:27], v12 offset:2048
    s_waitcnt lgkmcnt(3)
    v_mfma_f32_32x32x16_bf16 v[184:199], v[44:47], v[108:111], v[184:199]
    ds_read_b128 v[28:31], v13 offset:3072
    s_waitcnt vmcnt(15)
    s_waitcnt lgkmcnt(3)
    v_mfma_f32_32x32x16_bf16 v[136:151], v[16:19], v[112:115], v[136:151]
    ds_read_b128 v[32:35], v12 offset:4096
    s_waitcnt lgkmcnt(3)
    v_mfma_f32_32x32x16_bf16 v[152:167], v[20:23], v[112:115], v[152:167]
    ds_read_b128 v[36:39], v13 offset:5120
    s_waitcnt lgkmcnt(3)
    v_mfma_f32_32x32x16_bf16 v[168:183], v[24:27], v[112:115], v[168:183]
    ds_read_b128 v[40:43], v12 offset:6144
    s_waitcnt lgkmcnt(3)
    v_mfma_f32_32x32x16_bf16 v[184:199], v[28:31], v[112:115], v[184:199]
    ds_read_b128 v[44:47], v13 offset:7168
    s_waitcnt vmcnt(14)
    s_waitcnt lgkmcnt(3)
    v_mfma_f32_32x32x16_bf16 v[136:151], v[32:35], v[116:119], v[136:151]
    ds_read_b128 v[16:19], v12 offset:8192
    s_waitcnt lgkmcnt(3)
    v_mfma_f32_32x32x16_bf16 v[152:167], v[36:39], v[116:119], v[152:167]
    ds_read_b128 v[20:23], v13 offset:9216
    s_waitcnt lgkmcnt(3)
    v_mfma_f32_32x32x16_bf16 v[168:183], v[40:43], v[116:119], v[168:183]
    ds_read_b128 v[24:27], v12 offset:10240
    s_waitcnt lgkmcnt(3)
    v_mfma_f32_32x32x16_bf16 v[184:199], v[44:47], v[116:119], v[184:199]
    ds_read_b128 v[28:31], v13 offset:11264
    s_waitcnt vmcnt(13)
    s_waitcnt lgkmcnt(3)
    v_mfma_f32_32x32x16_bf16 v[136:151], v[16:19], v[120:123], v[136:151]
    ds_read_b128 v[32:35], v12 offset:12288
    s_waitcnt lgkmcnt(3)
    v_mfma_f32_32x32x16_bf16 v[152:167], v[20:23], v[120:123], v[152:167]
    ds_read_b128 v[36:39], v13 offset:13312
    s_waitcnt lgkmcnt(3)
    v_mfma_f32_32x32x16_bf16 v[168:183], v[24:27], v[120:123], v[168:183]
    ds_read_b128 v[40:43], v12 offset:14336
    s_waitcnt lgkmcnt(3)
    v_mfma_f32_32x32x16_bf16 v[184:199], v[28:31], v[120:123], v[184:199]
    ds_read_b128 v[44:47], v13 offset:15360
    s_waitcnt vmcnt(12)
    s_waitcnt lgkmcnt(3)
    v_mfma_f32_32x32x16_bf16 v[136:151], v[32:35], v[124:127], v[136:151]
    ds_read_b128 v[16:19], v12 offset:16384
    s_waitcnt lgkmcnt(3)
    v_mfma_f32_32x32x16_bf16 v[152:167], v[36:39], v[124:127], v[152:167]
    ds_read_b128 v[20:23], v13 offset:17408
    s_waitcnt lgkmcnt(3)
    v_mfma_f32_32x32x16_bf16 v[168:183], v[40:43], v[124:127], v[168:183]
    ds_read_b128 v[24:27], v12 offset:18432
    s_waitcnt lgkmcnt(3)
    v_mfma_f32_32x32x16_bf16 v[184:199], v[44:47], v[124:127], v[184:199]
    ds_read_b128 v[28:31], v13 offset:19456
    s_waitcnt vmcnt(11)
    s_waitcnt lgkmcnt(3)
    v_mfma_f32_32x32x16_bf16 v[136:151], v[16:19], v[128:131], v[136:151]
    ds_read_b128 v[32:35], v12 offset:20480
    s_waitcnt lgkmcnt(3)
    v_mfma_f32_32x32x16_bf16 v[152:167], v[20:23], v[128:131], v[152:167]
    ds_read_b128 v[36:39], v13 offset:21504
    s_waitcnt lgkmcnt(3)
    v_mfma_f32_32x32x16_bf16 v[168:183], v[24:27], v[128:131], v[168:183]
    ds_read_b128 v[40:43], v12 offset:22528
    s_waitcnt lgkmcnt(3)
    v_mfma_f32_32x32x16_bf16 v[184:199], v[28:31], v[128:131], v[184:199]
    ds_read_b128 v[44:47], v13 offset:23552
    s_waitcnt vmcnt(10)
    s_waitcnt lgkmcnt(3)
    v_mfma_f32_32x32x16_bf16 v[136:151], v[32:35], v[132:135], v[136:151]
    ds_read_b128 v[16:19], v12 offset:24576
    s_waitcnt lgkmcnt(3)
    v_mfma_f32_32x32x16_bf16 v[152:167], v[36:39], v[132:135], v[152:167]
    ds_read_b128 v[20:23], v13 offset:25600
    s_waitcnt lgkmcnt(3)
    v_mfma_f32_32x32x16_bf16 v[168:183], v[40:43], v[132:135], v[168:183]
    ds_read_b128 v[24:27], v12 offset:26624
    s_waitcnt lgkmcnt(3)
    v_mfma_f32_32x32x16_bf16 v[184:199], v[44:47], v[132:135], v[184:199]
    ds_read_b128 v[28:31], v13 offset:27648
    s_waitcnt vmcnt(9)
    s_waitcnt lgkmcnt(3)
    v_mfma_f32_32x32x16_bf16 v[136:151], v[16:19], v[48:51], v[136:151]
    ds_read_b128 v[32:35], v12 offset:28672
    s_waitcnt lgkmcnt(3)
    v_mfma_f32_32x32x16_bf16 v[152:167], v[20:23], v[48:51], v[152:167]
    ds_read_b128 v[36:39], v13 offset:29696
    s_waitcnt lgkmcnt(3)
    v_mfma_f32_32x32x16_bf16 v[168:183], v[24:27], v[48:51], v[168:183]
    ds_read_b128 v[40:43], v12 offset:30720
    s_waitcnt lgkmcnt(3)
    v_mfma_f32_32x32x16_bf16 v[184:199], v[28:31], v[48:51], v[184:199]
    ds_read_b128 v[44:47], v13 offset:31744
    s_waitcnt vmcnt(8)
    s_waitcnt lgkmcnt(3)
    v_mfma_f32_32x32x16_bf16 v[136:151], v[32:35], v[52:55], v[136:151]
    ds_read_b128 v[16:19], v12 offset:32768
    s_waitcnt lgkmcnt(3)
    v_mfma_f32_32x32x16_bf16 v[152:167], v[36:39], v[52:55], v[152:167]
    ds_read_b128 v[20:23], v13 offset:33792
    s_waitcnt lgkmcnt(3)
    v_mfma_f32_32x32x16_bf16 v[168:183], v[40:43], v[52:55], v[168:183]
    ds_read_b128 v[24:27], v12 offset:34816
    s_waitcnt lgkmcnt(3)
    v_mfma_f32_32x32x16_bf16 v[184:199], v[44:47], v[52:55], v[184:199]
    ds_read_b128 v[28:31], v13 offset:35840
    s_waitcnt vmcnt(7)
    s_waitcnt lgkmcnt(3)
    v_mfma_f32_32x32x16_bf16 v[136:151], v[16:19], v[56:59], v[136:151]
    ds_read_b128 v[32:35], v12 offset:36864
    s_waitcnt lgkmcnt(3)
    v_mfma_f32_32x32x16_bf16 v[152:167], v[20:23], v[56:59], v[152:167]
    ds_read_b128 v[36:39], v13 offset:37888
    s_waitcnt lgkmcnt(3)
    v_mfma_f32_32x32x16_bf16 v[168:183], v[24:27], v[56:59], v[168:183]
    ds_read_b128 v[40:43], v12 offset:38912
    s_waitcnt lgkmcnt(3)
    v_mfma_f32_32x32x16_bf16 v[184:199], v[28:31], v[56:59], v[184:199]
    ds_read_b128 v[44:47], v13 offset:39936
    s_waitcnt vmcnt(6)
    s_waitcnt lgkmcnt(3)
    v_mfma_f32_32x32x16_bf16 v[136:151], v[32:35], v[60:63], v[136:151]
    ds_read_b128 v[16:19], v12 offset:40960
    s_waitcnt lgkmcnt(3)
    v_mfma_f32_32x32x16_bf16 v[152:167], v[36:39], v[60:63], v[152:167]
    ds_read_b128 v[20:23], v13 offset:41984
    s_waitcnt lgkmcnt(3)
    v_mfma_f32_32x32x16_bf16 v[168:183], v[40:43], v[60:63], v[168:183]
    ds_read_b128 v[24:27], v12 offset:43008
    s_waitcnt lgkmcnt(3)
    v_mfma_f32_32x32x16_bf16 v[184:199], v[44:47], v[60:63], v[184:199]
    ds_read_b128 v[28:31], v13 offset:44032
    s_waitcnt vmcnt(5)
    s_waitcnt lgkmcnt(3)
    v_mfma_f32_32x32x16_bf16 v[136:151], v[16:19], v[64:67], v[136:151]
    ds_read_b128 v[32:35], v12 offset:45056
    s_waitcnt lgkmcnt(3)
    v_mfma_f32_32x32x16_bf16 v[152:167], v[20:23], v[64:67], v[152:167]
    ds_read_b128 v[36:39], v13 offset:46080
    s_waitcnt lgkmcnt(3)
    v_mfma_f32_32x32x16_bf16 v[168:183], v[24:27], v[64:67], v[168:183]
    ds_read_b128 v[40:43], v12 offset:47104
    s_waitcnt lgkmcnt(3)
    v_mfma_f32_32x32x16_bf16 v[184:199], v[28:31], v[64:67], v[184:199]
    ds_read_b128 v[44:47], v13 offset:48128
    s_waitcnt vmcnt(4)
    s_waitcnt lgkmcnt(3)
    v_mfma_f32_32x32x16_bf16 v[136:151], v[32:35], v[68:71], v[136:151]
    ds_read_b128 v[16:19], v12 offset:49152
    s_waitcnt lgkmcnt(3)
    v_mfma_f32_32x32x16_bf16 v[152:167], v[36:39], v[68:71], v[152:167]
    ds_read_b128 v[20:23], v13 offset:50176
    s_waitcnt lgkmcnt(3)
    v_mfma_f32_32x32x16_bf16 v[168:183], v[40:43], v[68:71], v[168:183]
    ds_read_b128 v[24:27], v12 offset:51200
    s_waitcnt lgkmcnt(3)
    v_mfma_f32_32x32x16_bf16 v[184:199], v[44:47], v[68:71], v[184:199]
    ds_read_b128 v[28:31], v13 offset:52224
    s_waitcnt vmcnt(3)
    s_waitcnt lgkmcnt(3)
    v_mfma_f32_32x32x16_bf16 v[136:151], v[16:19], v[72:75], v[136:151]
    ds_read_b128 v[32:35], v12 offset:53248
    s_waitcnt lgkmcnt(3)
    v_mfma_f32_32x32x16_bf16 v[152:167], v[20:23], v[72:75], v[152:167]
    ds_read_b128 v[36:39], v13 offset:54272
    s_waitcnt lgkmcnt(3)
    v_mfma_f32_32x32x16_bf16 v[168:183], v[24:27], v[72:75], v[168:183]
    ds_read_b128 v[40:43], v12 offset:55296
    s_waitcnt lgkmcnt(3)
    v_mfma_f32_32x32x16_bf16 v[184:199], v[28:31], v[72:75], v[184:199]
    ds_read_b128 v[44:47], v13 offset:56320
    s_waitcnt vmcnt(2)
    s_waitcnt lgkmcnt(3)
    v_mfma_f32_32x32x16_bf16 v[136:151], v[32:35], v[76:79], v[136:151]
    ds_read_b128 v[16:19], v12 offset:57344
    s_waitcnt lgkmcnt(3)
    v_mfma_f32_32x32x16_bf16 v[152:167], v[36:39], v[76:79], v[152:167]
    ds_read_b128 v[20:23], v13 offset:58368
    s_waitcnt lgkmcnt(3)
    v_mfma_f32_32x32x16_bf16 v[168:183], v[40:43], v[76:79], v[168:183]
    ds_read_b128 v[24:27], v12 offset:59392
    s_waitcnt lgkmcnt(3)
    v_mfma_f32_32x32x16_bf16 v[184:199], v[44:47], v[76:79], v[184:199]
    ds_read_b128 v[28:31], v13 offset:60416
    s_waitcnt vmcnt(1)
    s_waitcnt lgkmcnt(3)
    v_mfma_f32_32x32x16_bf16 v[136:151], v[16:19], v[80:83], v[136:151]
    ds_read_b128 v[32:35], v12 offset:61440
    s_waitcnt lgkmcnt(3)
    v_mfma_f32_32x32x16_bf16 v[152:167], v[20:23], v[80:83], v[152:167]
    ds_read_b128 v[36:39], v13 offset:62464
    s_waitcnt lgkmcnt(3)
    v_mfma_f32_32x32x16_bf16 v[168:183], v[24:27], v[80:83], v[168:183]
    ds_read_b128 v[40:43], v12 offset:63488
    s_waitcnt lgkmcnt(3)
    v_mfma_f32_32x32x16_bf16 v[184:199], v[28:31], v[80:83], v[184:199]
    ds_read_b128 v[44:47], v13 offset:64512
    s_waitcnt vmcnt(0)
    s_waitcnt lgkmcnt(3)
    v_mfma_f32_32x32x16_bf16 v[136:151], v[32:35], v[84:87], v[136:151]
    s_waitcnt lgkmcnt(2)
    v_mfma_f32_32x32x16_bf16 v[152:167], v[36:39], v[84:87], v[152:167]
    s_waitcnt lgkmcnt(1)
    v_mfma_f32_32x32x16_bf16 v[168:183], v[40:43], v[84:87], v[168:183]
    s_waitcnt lgkmcnt(0)
    v_mfma_f32_32x32x16_bf16 v[184:199], v[44:47], v[84:87], v[184:199]
    s_and_b32 s25, s57, 3
    s_lshl_b32 s25, s25, 19
    s_lshr_b32 s26, s57, 2
    s_lshl_b32 s26, s26, 21
    s_add_u32 s25, s25, s26
    s_lshl_b32 s26, s23, 10
    s_add_u32 s25, s25, s26
    s_mov_b32 s98, 0x3eb8aa3b
    s_cmp_lt_u32 s57, 4
    s_cbranch_scc0 P2_NOSC
    v_mul_f32 v136, s98, v136
    v_mul_f32 v137, s98, v137
    v_mul_f32 v138, s98, v138
    v_mul_f32 v139, s98, v139
    v_mul_f32 v140, s98, v140
    v_mul_f32 v141, s98, v141
    v_mul_f32 v142, s98, v142
    v_mul_f32 v143, s98, v143
    v_mul_f32 v144, s98, v144
    v_mul_f32 v145, s98, v145
    v_mul_f32 v146, s98, v146
    v_mul_f32 v147, s98, v147
    v_mul_f32 v148, s98, v148
    v_mul_f32 v149, s98, v149
    v_mul_f32 v150, s98, v150
    v_mul_f32 v151, s98, v151
    v_mul_f32 v152, s98, v152
    v_mul_f32 v153, s98, v153
    v_mul_f32 v154, s98, v154
    v_mul_f32 v155, s98, v155
    v_mul_f32 v156, s98, v156
    v_mul_f32 v157, s98, v157
    v_mul_f32 v158, s98, v158
    v_mul_f32 v159, s98, v159
    v_mul_f32 v160, s98, v160
    v_mul_f32 v161, s98, v161
    v_mul_f32 v162, s98, v162
    v_mul_f32 v163, s98, v163
    v_mul_f32 v164, s98, v164
    v_mul_f32 v165, s98, v165
    v_mul_f32 v166, s98, v166
    v_mul_f32 v167, s98, v167
    v_mul_f32 v168, s98, v168
    v_mul_f32 v169, s98, v169
    v_mul_f32 v170, s98, v170
    v_mul_f32 v171, s98, v171
    v_mul_f32 v172, s98, v172
    v_mul_f32 v173, s98, v173
    v_mul_f32 v174, s98, v174
    v_mul_f32 v175, s98, v175
    v_mul_f32 v176, s98, v176
    v_mul_f32 v177, s98, v177
    v_mul_f32 v178, s98, v178
    v_mul_f32 v179, s98, v179
    v_mul_f32 v180, s98, v180
    v_mul_f32 v181, s98, v181
    v_mul_f32 v182, s98, v182
    v_mul_f32 v183, s98, v183
    v_mul_f32 v184, s98, v184
    v_mul_f32 v185, s98, v185
    v_mul_f32 v186, s98, v186
    v_mul_f32 v187, s98, v187
    v_mul_f32 v188, s98, v188
    v_mul_f32 v189, s98, v189
    v_mul_f32 v190, s98, v190
    v_mul_f32 v191, s98, v191
    v_mul_f32 v192, s98, v192
    v_mul_f32 v193, s98, v193
    v_mul_f32 v194, s98, v194
    v_mul_f32 v195, s98, v195
    v_mul_f32 v196, s98, v196
    v_mul_f32 v197, s98, v197
    v_mul_f32 v198, s98, v198
    v_mul_f32 v199, s98, v199
P2_NOSC:
    v_cvt_pk_bf16_f32 v48, v136, v137
    v_cvt_pk_bf16_f32 v49, v138, v139
    v_cvt_pk_bf16_f32 v50, v140, v141
    v_cvt_pk_bf16_f32 v51, v142, v143
    v_cvt_pk_bf16_f32 v52, v144, v145
    v_cvt_pk_bf16_f32 v53, v146, v147
    v_cvt_pk_bf16_f32 v54, v148, v149
    v_cvt_pk_bf16_f32 v55, v150, v151
    buffer_store_dwordx4 v[48:51], v3, s[28:31], s25 offen sc1
    s_add_u32 s25, s25, 0x10000
    buffer_store_dwordx4 v[52:55], v3, s[28:31], s25 offen sc1
    s_add_u32 s25, s25, 0x10000
    v_cvt_pk_bf16_f32 v56, v152, v153
    v_cvt_pk_bf16_f32 v57, v154, v155
    v_cvt_pk_bf16_f32 v58, v156, v157
    v_cvt_pk_bf16_f32 v59, v158, v159
    v_cvt_pk_bf16_f32 v60, v160, v161
    v_cvt_pk_bf16_f32 v61, v162, v163
    v_cvt_pk_bf16_f32 v62, v164, v165
    v_cvt_pk_bf16_f32 v63, v166, v167
    buffer_store_dwordx4 v[56:59], v3, s[28:31], s25 offen sc1
    s_add_u32 s25, s25, 0x10000
    buffer_store_dwordx4 v[60:63], v3, s[28:31], s25 offen sc1
    s_add_u32 s25, s25, 0x10000
    v_cvt_pk_bf16_f32 v64, v168, v169
    v_cvt_pk_bf16_f32 v65, v170, v171
    v_cvt_pk_bf16_f32 v66, v172, v173
    v_cvt_pk_bf16_f32 v67, v174, v175
    v_cvt_pk_bf16_f32 v68, v176, v177
    v_cvt_pk_bf16_f32 v69, v178, v179
    v_cvt_pk_bf16_f32 v70, v180, v181
    v_cvt_pk_bf16_f32 v71, v182, v183
    buffer_store_dwordx4 v[64:67], v3, s[28:31], s25 offen sc1
    s_add_u32 s25, s25, 0x10000
    buffer_store_dwordx4 v[68:71], v3, s[28:31], s25 offen sc1
    s_add_u32 s25, s25, 0x10000
    v_cvt_pk_bf16_f32 v72, v184, v185
    v_cvt_pk_bf16_f32 v73, v186, v187
    v_cvt_pk_bf16_f32 v74, v188, v189
    v_cvt_pk_bf16_f32 v75, v190, v191
    v_cvt_pk_bf16_f32 v76, v192, v193
    v_cvt_pk_bf16_f32 v77, v194, v195
    v_cvt_pk_bf16_f32 v78, v196, v197
    v_cvt_pk_bf16_f32 v79, v198, v199
    buffer_store_dwordx4 v[72:75], v3, s[28:31], s25 offen sc1
    s_add_u32 s25, s25, 0x10000
    buffer_store_dwordx4 v[76:79], v3, s[28:31], s25 offen sc1
    s_add_u32 s25, s25, 0x10000
    s_branch P2_CPUB
P2_V:
    s_mov_b32 s25, s24
    buffer_load_dwordx4 v[48:51], v3, s[8:11], s25 offen offset:0 sc1
    buffer_load_dwordx4 v[52:55], v3, s[8:11], s25 offen offset:1024 sc1
    buffer_load_dwordx4 v[56:59], v3, s[8:11], s25 offen offset:2048 sc1
    buffer_load_dwordx4 v[60:63], v3, s[8:11], s25 offen offset:3072 sc1
    s_add_u32 s25, s25, 4096
    buffer_load_dwordx4 v[64:67], v3, s[8:11], s25 offen offset:0 sc1
    buffer_load_dwordx4 v[68:71], v3, s[8:11], s25 offen offset:1024 sc1
    ds_read_b128 v[16:19], v8 offset:0
    ds_read_b128 v[20:23], v9 offset:1024
    ds_read_b128 v[24:27], v8 offset:2048
    ds_read_b128 v[28:31], v9 offset:3072
    s_waitcnt vmcnt(5)
    s_waitcnt lgkmcnt(3)
    v_mfma_f32_32x32x16_bf16 v[136:151], v[48:51], v[16:19], 0
    ds_read_b128 v[32:35], v8 offset:4096
    s_waitcnt lgkmcnt(3)
    v_mfma_f32_32x32x16_bf16 v[152:167], v[48:51], v[20:23], 0
    ds_read_b128 v[36:39], v9 offset:5120
    buffer_load_dwordx4 v[72:75], v3, s[8:11], s25 offen offset:2048 sc1
    s_waitcnt lgkmcnt(3)
    v_mfma_f32_32x32x16_bf16 v[168:183], v[48:51], v[24:27], 0
    ds_read_b128 v[40:43], v8 offset:6144
    s_waitcnt lgkmcnt(3)
    v_mfma_f32_32x32x16_bf16 v[184:199], v[48:51], v[28:31], 0
    ds_read_b128 v[44:47], v9 offset:7168
    buffer_load_dwordx4 v[76:79], v3, s[8:11], s25 offen offset:3072 sc1
    s_add_u32 s25, s25, 4096
    s_waitcnt vmcnt(6)
    s_waitcnt lgkmcnt(3)
    v_mfma_f32_32x32x16_bf16 v[136:151], v[52:55], v[32:35], v[136:151]
    ds_read_b128 v[16:19], v8 offset:8192
    s_waitcnt lgkmcnt(3)
    v_mfma_f32_32x32x16_bf16 v[152:167], v[52:55], v[36:39], v[152:167]
    ds_read_b128 v[20:23], v9 offset:9216
    buffer_load_dwordx4 v[80:83], v3, s[8:11], s25 offen offset:0 sc1
    s_waitcnt lgkmcnt(3)
    v_mfma_f32_32x32x16_bf16 v[168:183], v[52:55], v[40:43], v[168:183]
    ds_read_b128 v[24:27], v8 offset:10240
    s_waitcnt lgkmcnt(3)
    v_mfma_f32_32x32x16_bf16 v[184:199], v[52:55], v[44:47], v[184:199]
    ds_read_b128 v[28:31], v9 offset:11264
    buffer_load_dwordx4 v[84:87], v3, s[8:11], s25 offen offset:1024 sc1
    s_waitcnt vmcnt(7)
    s_waitcnt lgkmcnt(3)
    v_mfma_f32_32x32x16_bf16 v[136:151], v[56:59], v[16:19], v[136:151]
    ds_read_b128 v[32:35], v8 offset:12288
    s_waitcnt lgkmcnt(3)
    v_mfma_f32_32x32x16_bf16 v[152:167], v[56:59], v[20:23], v[152:167]
    ds_read_b128 v[36:39], v9 offset:13312
    buffer_load_dwordx4 v[88:91], v3, s[8:11], s25 offen offset:2048 sc1
    s_waitcnt lgkmcnt(3)
    v_mfma_f32_32x32x16_bf16 v[168:183], v[56:59], v[24:27], v[168:183]
    ds_read_b128 v[40:43], v8 offset:14336
    s_waitcnt lgkmcnt(3)
    v_mfma_f32_32x32x16_bf16 v[184:199], v[56:59], v[28:31], v[184:199]
    ds_read_b128 v[44:47], v9 offset:15360
    buffer_load_dwordx4 v[92:95], v3, s[8:11], s25 offen offset:3072 sc1
    s_add_u32 s25, s25, 4096
    s_waitcnt vmcnt(8)
    s_waitcnt lgkmcnt(3)
    v_mfma_f32_32x32x16_bf16 v[136:151], v[60:63], v[32:35], v[136:151]
    ds_read_b128 v[16:19], v8 offset:16384
    s_waitcnt lgkmcnt(3)
    v_mfma_f32_32x32x16_bf16 v[152:167], v[60:63], v[36:39], v[152:167]
    ds_read_b128 v[20:23], v9 offset:17408
    buffer_load_dwordx4 v[96:99], v3, s[8:11], s25 offen offset:0 sc1
    s_waitcnt lgkmcnt(3)
    v_mfma_f32_32x32x16_bf16 v[168:183], v[60:63], v[40:43], v[168:183]
    ds_read_b128 v[24:27], v8 offset:18432
    s_waitcnt lgkmcnt(3)
    v_mfma_f32_32x32x16_bf16 v[184:199], v[60:63], v[44:47], v[184:199]
    ds_read_b128 v[28:31], v9 offset:19456
    buffer_load_dwordx4 v[100:103], v3, s[8:11], s25 offen offset:1024 sc1
    s_waitcnt vmcnt(9)
    s_waitcnt lgkmcnt(3)
    v_mfma_f32_32x32x16_bf16 v[136:151], v[64:67], v[16:19], v[136:151]
    ds_read_b128 v[32:35], v8 offset:20480
    s_waitcnt lgkmcnt(3)
    v_mfma_f32_32x32x16_bf16 v[152:167], v[64:67], v[20:23], v[152:167]
    ds_read_b128 v[36:39], v9 offset:21504
    buffer_load_dwordx4 v[104:107], v3, s[8:11], s25 offen offset:2048 sc1
    s_waitcnt lgkmcnt(3)
    v_mfma_f32_32x32x16_bf16 v[168:183], v[64:67], v[24:27], v[168:183]
    ds_read_b128 v[40:43], v8 offset:22528
    s_waitcnt lgkmcnt(3)
    v_mfma_f32_32x32x16_bf16 v[184:199], v[64:67], v[28:31], v[184:199]
    ds_read_b128 v[44:47], v9 offset:23552
    buffer_load_dwordx4 v[108:111], v3, s[8:11], s25 offen offset:3072 sc1
    s_add_u32 s25, s25, 4096
    s_waitcnt vmcnt(10)
    s_waitcnt lgkmcnt(3)
    v_mfma_f32_32x32x16_bf16 v[136:151], v[68:71], v[32:35], v[136:151]
    ds_read_b128 v[16:19], v8 offset:24576
    s_waitcnt lgkmcnt(3)
    v_mfma_f32_32x32x16_bf16 v[152:167], v[68:71], v[36:39], v[152:167]
    ds_read_b128 v[20:23], v9 offset:25600
    buffer_load_dwordx4 v[112:115], v3, s[8:11], s25 offen offset:0 sc1
    s_waitcnt lgkmcnt(3)
    v_mfma_f32_32x32x16_bf16 v[168:183], v[68:71], v[40:43], v[168:183]
    ds_read_b128 v[24:27], v8 offset:26624
    s_waitcnt lgkmcnt(3)
    v_mfma_f32_32x32x16_bf16 v[184:199], v[68:71], v[44:47], v[184:199]
    ds_read_b128 v[28:31], v9 offset:27648
    buffer_load_dwordx4 v[116:119], v3, s[8:11], s25 offen offset:1024 sc1
    s_waitcnt vmcnt(11)
    s_waitcnt lgkmcnt(3)
    v_mfma_f32_32x32x16_bf16 v[136:151], v[72:75], v[16:19], v[136:151]
    ds_read_b128 v[32:35], v8 offset:28672
    s_waitcnt lgkmcnt(3)
    v_mfma_f32_32x32x16_bf16 v[152:167], v[72:75], v[20:23], v[152:167]
    ds_read_b128 v[36:39], v9 offset:29696
    buffer_load_dwordx4 v[120:123], v3, s[8:11], s25 offen offset:2048 sc1
    s_waitcnt lgkmcnt(3)
    v_mfma_f32_32x32x16_bf16 v[168:183], v[72:75], v[24:27], v[168:183]
    ds_read_b128 v[40:43], v8 offset:30720
    s_waitcnt lgkmcnt(3)
    v_mfma_f32_32x32x16_bf16 v[184:199], v[72:75], v[28:31], v[184:199]
    ds_read_b128 v[44:47], v9 offset:31744
    buffer_load_dwordx4 v[124:127], v3, s[8:11], s25 offen offset:3072 sc1
    s_add_u32 s25, s25, 4096
    s_waitcnt vmcnt(12)
    s_waitcnt lgkmcnt(3)
    v_mfma_f32_32x32x16_bf16 v[136:151], v[76:79], v[32:35], v[136:151]
    ds_read_b128 v[16:19], v8 offset:32768
    s_waitcnt lgkmcnt(3)
    v_mfma_f32_32x32x16_bf16 v[152:167], v[76:79], v[36:39], v[152:167]
    ds_read_b128 v[20:23], v9 offset:33792
    buffer_load_dwordx4 v[128:131], v3, s[8:11], s25 offen offset:0 sc1
    s_waitcnt lgkmcnt(3)
    v_mfma_f32_32x32x16_bf16 v[168:183], v[76:79], v[40:43], v[168:183]
    ds_read_b128 v[24:27], v8 offset:34816
    s_waitcnt lgkmcnt(3)
    v_mfma_f32_32x32x16_bf16 v[184:199], v[76:79], v[44:47], v[184:199]
    ds_read_b128 v[28:31], v9 offset:35840
    buffer_load_dwordx4 v[132:135], v3, s[8:11], s25 offen offset:1024 sc1
    s_waitcnt vmcnt(13)
    s_waitcnt lgkmcnt(3)
    v_mfma_f32_32x32x16_bf16 v[136:151], v[80:83], v[16:19], v[136:151]
    ds_read_b128 v[32:35], v8 offset:36864
    s_waitcnt lgkmcnt(3)
    v_mfma_f32_32x32x16_bf16 v[152:167], v[80:83], v[20:23], v[152:167]
    ds_read_b128 v[36:39], v9 offset:37888
    buffer_load_dwordx4 v[48:51], v3, s[8:11], s25 offen offset:2048 sc1
    s_waitcnt lgkmcnt(3)
    v_mfma_f32_32x32x16_bf16 v[168:183], v[80:83], v[24:27], v[168:183]
    ds_read_b128 v[40:43], v8 offset:38912
    s_waitcnt lgkmcnt(3)
    v_mfma_f32_32x32x16_bf16 v[184:199], v[80:83], v[28:31], v[184:199]
    ds_read_b128 v[44:47], v9 offset:39936
    buffer_load_dwordx4 v[52:55], v3, s[8:11], s25 offen offset:3072 sc1
    s_add_u32 s25, s25, 4096
    s_waitcnt vmcnt(14)
    s_waitcnt lgkmcnt(3)
    v_mfma_f32_32x32x16_bf16 v[136:151], v[84:87], v[32:35], v[136:151]
    ds_read_b128 v[16:19], v8 offset:40960
    s_waitcnt lgkmcnt(3)
    v_mfma_f32_32x32x16_bf16 v[152:167], v[84:87], v[36:39], v[152:167]
    ds_read_b128 v[20:23], v9 offset:41984
    buffer_load_dwordx4 v[56:59], v3, s[8:11], s25 offen offset:0 sc1
    s_waitcnt lgkmcnt(3)
    v_mfma_f32_32x32x16_bf16 v[168:183], v[84:87], v[40:43], v[168:183]
    ds_read_b128 v[24:27], v8 offset:43008
    s_waitcnt lgkmcnt(3)
    v_mfma_f32_32x32x16_bf16 v[184:199], v[84:87], v[44:47], v[184:199]
    ds_read_b128 v[28:31], v9 offset:44032
    buffer_load_dwordx4 v[60:63], v3, s[8:11], s25 offen offset:1024 sc1
    s_waitcnt vmcnt(15)
    s_waitcnt lgkmcnt(3)
    v_mfma_f32_32x32x16_bf16 v[136:151], v[88:91], v[16:19], v[136:151]
    ds_read_b128 v[32:35], v8 offset:45056
    s_waitcnt lgkmcnt(3)
    v_mfma_f32_32x32x16_bf16 v[152:167], v[88:91], v[20:23], v[152:167]
    ds_read_b128 v[36:39], v9 offset:46080
    buffer_load_dwordx4 v[64:67], v3, s[8:11], s25 offen offset:2048 sc1
    s_waitcnt lgkmcnt(3)
    v_mfma_f32_32x32x16_bf16 v[168:183], v[88:91], v[24:27], v[168:183]
    ds_read_b128 v[40:43], v8 offset:47104
    s_waitcnt lgkmcnt(3)
    v_mfma_f32_32x32x16_bf16 v[184:199], v[88:91], v[28:31], v[184:199]
    ds_read_b128 v[44:47], v9 offset:48128
    buffer_load_dwordx4 v[68:71], v3, s[8:11], s25 offen offset:3072 sc1
    s_add_u32 s25, s25, 4096
    s_waitcnt vmcnt(16)
    s_waitcnt lgkmcnt(3)
    v_mfma_f32_32x32x16_bf16 v[136:151], v[92:95], v[32:35], v[136:151]
    ds_read_b128 v[16:19], v8 offset:49152
    s_waitcnt lgkmcnt(3)
    v_mfma_f32_32x32x16_bf16 v[152:167], v[92:95], v[36:39], v[152:167]
    ds_read_b128 v[20:23], v9 offset:50176
    buffer_load_dwordx4 v[72:75], v3, s[8:11], s25 offen offset:0 sc1
    s_waitcnt lgkmcnt(3)
    v_mfma_f32_32x32x16_bf16 v[168:183], v[92:95], v[40:43], v[168:183]
    ds_read_b128 v[24:27], v8 offset:51200
    s_waitcnt lgkmcnt(3)
    v_mfma_f32_32x32x16_bf16 v[184:199], v[92:95], v[44:47], v[184:199]
    ds_read_b128 v[28:31], v9 offset:52224
    buffer_load_dwordx4 v[76:79], v3, s[8:11], s25 offen offset:1024 sc1
    s_waitcnt vmcnt(17)
    s_waitcnt lgkmcnt(3)
    v_mfma_f32_32x32x16_bf16 v[136:151], v[96:99], v[16:19], v[136:151]
    ds_read_b128 v[32:35], v8 offset:53248
    s_waitcnt lgkmcnt(3)
    v_mfma_f32_32x32x16_bf16 v[152:167], v[96:99], v[20:23], v[152:167]
    ds_read_b128 v[36:39], v9 offset:54272
    buffer_load_dwordx4 v[80:83], v3, s[8:11], s25 offen offset:2048 sc1
    s_waitcnt lgkmcnt(3)
    v_mfma_f32_32x32x16_bf16 v[168:183], v[96:99], v[24:27], v[168:183]
    ds_read_b128 v[40:43], v8 offset:55296
    s_waitcnt lgkmcnt(3)
    v_mfma_f32_32x32x16_bf16 v[184:199], v[96:99], v[28:31], v[184:199]
    ds_read_b128 v[44:47], v9 offset:56320
    buffer_load_dwordx4 v[84:87], v3, s[8:11], s25 offen offset:3072 sc1
    s_add_u32 s25, s25, 4096
    s_waitcnt vmcnt(18)
    s_waitcnt lgkmcnt(3)
    v_mfma_f32_32x32x16_bf16 v[136:151], v[100:103], v[32:35], v[136:151]
    ds_read_b128 v[16:19], v8 offset:57344
    s_waitcnt lgkmcnt(3)
    v_mfma_f32_32x32x16_bf16 v[152:167], v[100:103], v[36:39], v[152:167]
    ds_read_b128 v[20:23], v9 offset:58368
    s_waitcnt lgkmcnt(3)
    v_mfma_f32_32x32x16_bf16 v[168:183], v[100:103], v[40:43], v[168:183]
    ds_read_b128 v[24:27], v8 offset:59392
    s_waitcnt lgkmcnt(3)
    v_mfma_f32_32x32x16_bf16 v[184:199], v[100:103], v[44:47], v[184:199]
    ds_read_b128 v[28:31], v9 offset:60416
    s_waitcnt vmcnt(17)
    s_waitcnt lgkmcnt(3)
    v_mfma_f32_32x32x16_bf16 v[136:151], v[104:107], v[16:19], v[136:151]
    ds_read_b128 v[32:35], v8 offset:61440
    s_waitcnt lgkmcnt(3)
    v_mfma_f32_32x32x16_bf16 v[152:167], v[104:107], v[20:23], v[152:167]
    ds_read_b128 v[36:39], v9 offset:62464
    s_waitcnt lgkmcnt(3)
    v_mfma_f32_32x32x16_bf16 v[168:183], v[104:107], v[24:27], v[168:183]
    ds_read_b128 v[40:43], v8 offset:63488
    s_waitcnt lgkmcnt(3)
    v_mfma_f32_32x32x16_bf16 v[184:199], v[104:107], v[28:31], v[184:199]
    ds_read_b128 v[44:47], v9 offset:64512
    s_waitcnt vmcnt(16)
    s_waitcnt lgkmcnt(3)
    v_mfma_f32_32x32x16_bf16 v[136:151], v[108:111], v[32:35], v[136:151]
    ds_read_b128 v[16:19], v12 offset:0
    s_waitcnt lgkmcnt(3)
    v_mfma_f32_32x32x16_bf16 v[152:167], v[108:111], v[36:39], v[152:167]
    ds_read_b128 v[20:23], v13 offset:1024
    s_waitcnt lgkmcnt(3)
    v_mfma_f32_32x32x16_bf16 v[168:183], v[108:111], v[40:43], v[168:183]
    ds_read_b128 v[24:27], v12 offset:2048
    s_waitcnt lgkmcnt(3)
    v_mfma_f32_32x32x16_bf16 v[184:199], v[108:111], v[44:47], v[184:199]
    ds_read_b128 v[28:31], v13 offset:3072
    s_waitcnt vmcnt(15)
    s_waitcnt lgkmcnt(3)
    v_mfma_f32_32x32x16_bf16 v[136:151], v[112:115], v[16:19], v[136:151]
    ds_read_b128 v[32:35], v12 offset:4096
    s_waitcnt lgkmcnt(3)
    v_mfma_f32_32x32x16_bf16 v[152:167], v[112:115], v[20:23], v[152:167]
    ds_read_b128 v[36:39], v13 offset:5120
    s_waitcnt lgkmcnt(3)
    v_mfma_f32_32x32x16_bf16 v[168:183], v[112:115], v[24:27], v[168:183]
    ds_read_b128 v[40:43], v12 offset:6144
    s_waitcnt lgkmcnt(3)
    v_mfma_f32_32x32x16_bf16 v[184:199], v[112:115], v[28:31], v[184:199]
    ds_read_b128 v[44:47], v13 offset:7168
    s_waitcnt vmcnt(14)
    s_waitcnt lgkmcnt(3)
    v_mfma_f32_32x32x16_bf16 v[136:151], v[116:119], v[32:35], v[136:151]
    ds_read_b128 v[16:19], v12 offset:8192
    s_waitcnt lgkmcnt(3)
    v_mfma_f32_32x32x16_bf16 v[152:167], v[116:119], v[36:39], v[152:167]
    ds_read_b128 v[20:23], v13 offset:9216
    s_waitcnt lgkmcnt(3)
    v_mfma_f32_32x32x16_bf16 v[168:183], v[116:119], v[40:43], v[168:183]
    ds_read_b128 v[24:27], v12 offset:10240
    s_waitcnt lgkmcnt(3)
    v_mfma_f32_32x32x16_bf16 v[184:199], v[116:119], v[44:47], v[184:199]
    ds_read_b128 v[28:31], v13 offset:11264
    s_waitcnt vmcnt(13)
    s_waitcnt lgkmcnt(3)
    v_mfma_f32_32x32x16_bf16 v[136:151], v[120:123], v[16:19], v[136:151]
    ds_read_b128 v[32:35], v12 offset:12288
    s_waitcnt lgkmcnt(3)
    v_mfma_f32_32x32x16_bf16 v[152:167], v[120:123], v[20:23], v[152:167]
    ds_read_b128 v[36:39], v13 offset:13312
    s_waitcnt lgkmcnt(3)
    v_mfma_f32_32x32x16_bf16 v[168:183], v[120:123], v[24:27], v[168:183]
    ds_read_b128 v[40:43], v12 offset:14336
    s_waitcnt lgkmcnt(3)
    v_mfma_f32_32x32x16_bf16 v[184:199], v[120:123], v[28:31], v[184:199]
    ds_read_b128 v[44:47], v13 offset:15360
    s_waitcnt vmcnt(12)
    s_waitcnt lgkmcnt(3)
    v_mfma_f32_32x32x16_bf16 v[136:151], v[124:127], v[32:35], v[136:151]
    ds_read_b128 v[16:19], v12 offset:16384
    s_waitcnt lgkmcnt(3)
    v_mfma_f32_32x32x16_bf16 v[152:167], v[124:127], v[36:39], v[152:167]
    ds_read_b128 v[20:23], v13 offset:17408
    s_waitcnt lgkmcnt(3)
    v_mfma_f32_32x32x16_bf16 v[168:183], v[124:127], v[40:43], v[168:183]
    ds_read_b128 v[24:27], v12 offset:18432
    s_waitcnt lgkmcnt(3)
    v_mfma_f32_32x32x16_bf16 v[184:199], v[124:127], v[44:47], v[184:199]
    ds_read_b128 v[28:31], v13 offset:19456
    s_waitcnt vmcnt(11)
    s_waitcnt lgkmcnt(3)
    v_mfma_f32_32x32x16_bf16 v[136:151], v[128:131], v[16:19], v[136:151]
    ds_read_b128 v[32:35], v12 offset:20480
    s_waitcnt lgkmcnt(3)
    v_mfma_f32_32x32x16_bf16 v[152:167], v[128:131], v[20:23], v[152:167]
    ds_read_b128 v[36:39], v13 offset:21504
    s_waitcnt lgkmcnt(3)
    v_mfma_f32_32x32x16_bf16 v[168:183], v[128:131], v[24:27], v[168:183]
    ds_read_b128 v[40:43], v12 offset:22528
    s_waitcnt lgkmcnt(3)
    v_mfma_f32_32x32x16_bf16 v[184:199], v[128:131], v[28:31], v[184:199]
    ds_read_b128 v[44:47], v13 offset:23552
    s_waitcnt vmcnt(10)
    s_waitcnt lgkmcnt(3)
    v_mfma_f32_32x32x16_bf16 v[136:151], v[132:135], v[32:35], v[136:151]
    ds_read_b128 v[16:19], v12 offset:24576
    s_waitcnt lgkmcnt(3)
    v_mfma_f32_32x32x16_bf16 v[152:167], v[132:135], v[36:39], v[152:167]
    ds_read_b128 v[20:23], v13 offset:25600
    s_waitcnt lgkmcnt(3)
    v_mfma_f32_32x32x16_bf16 v[168:183], v[132:135], v[40:43], v[168:183]
    ds_read_b128 v[24:27], v12 offset:26624
    s_waitcnt lgkmcnt(3)
    v_mfma_f32_32x32x16_bf16 v[184:199], v[132:135], v[44:47], v[184:199]
    ds_read_b128 v[28:31], v13 offset:27648
    s_waitcnt vmcnt(9)
    s_waitcnt lgkmcnt(3)
    v_mfma_f32_32x32x16_bf16 v[136:151], v[48:51], v[16:19], v[136:151]
    ds_read_b128 v[32:35], v12 offset:28672
    s_waitcnt lgkmcnt(3)
    v_mfma_f32_32x32x16_bf16 v[152:167], v[48:51], v[20:23], v[152:167]
    ds_read_b128 v[36:39], v13 offset:29696
    s_waitcnt lgkmcnt(3)
    v_mfma_f32_32x32x16_bf16 v[168:183], v[48:51], v[24:27], v[168:183]
    ds_read_b128 v[40:43], v12 offset:30720
    s_waitcnt lgkmcnt(3)
    v_mfma_f32_32x32x16_bf16 v[184:199], v[48:51], v[28:31], v[184:199]
    ds_read_b128 v[44:47], v13 offset:31744
    s_waitcnt vmcnt(8)
    s_waitcnt lgkmcnt(3)
    v_mfma_f32_32x32x16_bf16 v[136:151], v[52:55], v[32:35], v[136:151]
    ds_read_b128 v[16:19], v12 offset:32768
    s_waitcnt lgkmcnt(3)
    v_mfma_f32_32x32x16_bf16 v[152:167], v[52:55], v[36:39], v[152:167]
    ds_read_b128 v[20:23], v13 offset:33792
    s_waitcnt lgkmcnt(3)
    v_mfma_f32_32x32x16_bf16 v[168:183], v[52:55], v[40:43], v[168:183]
    ds_read_b128 v[24:27], v12 offset:34816
    s_waitcnt lgkmcnt(3)
    v_mfma_f32_32x32x16_bf16 v[184:199], v[52:55], v[44:47], v[184:199]
    ds_read_b128 v[28:31], v13 offset:35840
    s_waitcnt vmcnt(7)
    s_waitcnt lgkmcnt(3)
    v_mfma_f32_32x32x16_bf16 v[136:151], v[56:59], v[16:19], v[136:151]
    ds_read_b128 v[32:35], v12 offset:36864
    s_waitcnt lgkmcnt(3)
    v_mfma_f32_32x32x16_bf16 v[152:167], v[56:59], v[20:23], v[152:167]
    ds_read_b128 v[36:39], v13 offset:37888
    s_waitcnt lgkmcnt(3)
    v_mfma_f32_32x32x16_bf16 v[168:183], v[56:59], v[24:27], v[168:183]
    ds_read_b128 v[40:43], v12 offset:38912
    s_waitcnt lgkmcnt(3)
    v_mfma_f32_32x32x16_bf16 v[184:199], v[56:59], v[28:31], v[184:199]
    ds_read_b128 v[44:47], v13 offset:39936
    s_waitcnt vmcnt(6)
    s_waitcnt lgkmcnt(3)
    v_mfma_f32_32x32x16_bf16 v[136:151], v[60:63], v[32:35], v[136:151]
    ds_read_b128 v[16:19], v12 offset:40960
    s_waitcnt lgkmcnt(3)
    v_mfma_f32_32x32x16_bf16 v[152:167], v[60:63], v[36:39], v[152:167]
    ds_read_b128 v[20:23], v13 offset:41984
    s_waitcnt lgkmcnt(3)
    v_mfma_f32_32x32x16_bf16 v[168:183], v[60:63], v[40:43], v[168:183]
    ds_read_b128 v[24:27], v12 offset:43008
    s_waitcnt lgkmcnt(3)
    v_mfma_f32_32x32x16_bf16 v[184:199], v[60:63], v[44:47], v[184:199]
    ds_read_b128 v[28:31], v13 offset:44032
    s_waitcnt vmcnt(5)
    s_waitcnt lgkmcnt(3)
    v_mfma_f32_32x32x16_bf16 v[136:151], v[64:67], v[16:19], v[136:151]
    ds_read_b128 v[32:35], v12 offset:45056
    s_waitcnt lgkmcnt(3)
    v_mfma_f32_32x32x16_bf16 v[152:167], v[64:67], v[20:23], v[152:167]
    ds_read_b128 v[36:39], v13 offset:46080
    s_waitcnt lgkmcnt(3)
    v_mfma_f32_32x32x16_bf16 v[168:183], v[64:67], v[24:27], v[168:183]
    ds_read_b128 v[40:43], v12 offset:47104
    s_waitcnt lgkmcnt(3)
    v_mfma_f32_32x32x16_bf16 v[184:199], v[64:67], v[28:31], v[184:199]
    ds_read_b128 v[44:47], v13 offset:48128
    s_waitcnt vmcnt(4)
    s_waitcnt lgkmcnt(3)
    v_mfma_f32_32x32x16_bf16 v[136:151], v[68:71], v[32:35], v[136:151]
    ds_read_b128 v[16:19], v12 offset:49152
    s_waitcnt lgkmcnt(3)
    v_mfma_f32_32x32x16_bf16 v[152:167], v[68:71], v[36:39], v[152:167]
    ds_read_b128 v[20:23], v13 offset:50176
    s_waitcnt lgkmcnt(3)
    v_mfma_f32_32x32x16_bf16 v[168:183], v[68:71], v[40:43], v[168:183]
    ds_read_b128 v[24:27], v12 offset:51200
    s_waitcnt lgkmcnt(3)
    v_mfma_f32_32x32x16_bf16 v[184:199], v[68:71], v[44:47], v[184:199]
    ds_read_b128 v[28:31], v13 offset:52224
    s_waitcnt vmcnt(3)
    s_waitcnt lgkmcnt(3)
    v_mfma_f32_32x32x16_bf16 v[136:151], v[72:75], v[16:19], v[136:151]
    ds_read_b128 v[32:35], v12 offset:53248
    s_waitcnt lgkmcnt(3)
    v_mfma_f32_32x32x16_bf16 v[152:167], v[72:75], v[20:23], v[152:167]
    ds_read_b128 v[36:39], v13 offset:54272
    s_waitcnt lgkmcnt(3)
    v_mfma_f32_32x32x16_bf16 v[168:183], v[72:75], v[24:27], v[168:183]
    ds_read_b128 v[40:43], v12 offset:55296
    s_waitcnt lgkmcnt(3)
    v_mfma_f32_32x32x16_bf16 v[184:199], v[72:75], v[28:31], v[184:199]
    ds_read_b128 v[44:47], v13 offset:56320
    s_waitcnt vmcnt(2)
    s_waitcnt lgkmcnt(3)
    v_mfma_f32_32x32x16_bf16 v[136:151], v[76:79], v[32:35], v[136:151]
    ds_read_b128 v[16:19], v12 offset:57344
    s_waitcnt lgkmcnt(3)
    v_mfma_f32_32x32x16_bf16 v[152:167], v[76:79], v[36:39], v[152:167]
    ds_read_b128 v[20:23], v13 offset:58368
    s_waitcnt lgkmcnt(3)
    v_mfma_f32_32x32x16_bf16 v[168:183], v[76:79], v[40:43], v[168:183]
    ds_read_b128 v[24:27], v12 offset:59392
    s_waitcnt lgkmcnt(3)
    v_mfma_f32_32x32x16_bf16 v[184:199], v[76:79], v[44:47], v[184:199]
    ds_read_b128 v[28:31], v13 offset:60416
    s_waitcnt vmcnt(1)
    s_waitcnt lgkmcnt(3)
    v_mfma_f32_32x32x16_bf16 v[136:151], v[80:83], v[16:19], v[136:151]
    ds_read_b128 v[32:35], v12 offset:61440
    s_waitcnt lgkmcnt(3)
    v_mfma_f32_32x32x16_bf16 v[152:167], v[80:83], v[20:23], v[152:167]
    ds_read_b128 v[36:39], v13 offset:62464
    s_waitcnt lgkmcnt(3)
    v_mfma_f32_32x32x16_bf16 v[168:183], v[80:83], v[24:27], v[168:183]
    ds_read_b128 v[40:43], v12 offset:63488
    s_waitcnt lgkmcnt(3)
    v_mfma_f32_32x32x16_bf16 v[184:199], v[80:83], v[28:31], v[184:199]
    ds_read_b128 v[44:47], v13 offset:64512
    s_waitcnt vmcnt(0)
    s_waitcnt lgkmcnt(3)
    v_mfma_f32_32x32x16_bf16 v[136:151], v[84:87], v[32:35], v[136:151]
    s_waitcnt lgkmcnt(2)
    v_mfma_f32_32x32x16_bf16 v[152:167], v[84:87], v[36:39], v[152:167]
    s_waitcnt lgkmcnt(1)
    v_mfma_f32_32x32x16_bf16 v[168:183], v[84:87], v[40:43], v[168:183]
    s_waitcnt lgkmcnt(0)
    v_mfma_f32_32x32x16_bf16 v[184:199], v[84:87], v[44:47], v[184:199]
    s_and_b32 s25, s57, 3
    s_lshl_b32 s25, s25, 19
    s_add_u32 s25, s25, 4194304
    s_lshl_b32 s26, s23, 10
    s_add_u32 s25, s25, s26
    v_bfe_u32 v5, v2, 4, 1
    v_lshlrev_b32 v5, 16, v5
    v_lshrrev_b32 v6, 5, v2
    v_lshl_add_u32 v5, v6, 8, v5
    v_and_b32 v6, 15, v2
    v_lshl_add_u32 v5, v6, 4, v5
    v_cvt_pk_bf16_f32 v48, v136, v137
    v_cvt_pk_bf16_f32 v49, v138, v139
    v_cvt_pk_bf16_f32 v50, v140, v141
    v_cvt_pk_bf16_f32 v51, v142, v143
    v_cvt_pk_bf16_f32 v52, v144, v145
    v_cvt_pk_bf16_f32 v53, v146, v147
    v_cvt_pk_bf16_f32 v54, v148, v149
    v_cvt_pk_bf16_f32 v55, v150, v151
    buffer_store_dwordx4 v[48:51], v5, s[28:31], s25 offen sc1
    buffer_store_dwordx4 v[52:55], v5, s[28:31], s25 offen offset:512 sc1
    s_add_u32 s25, s25, 0x20000
    v_cvt_pk_bf16_f32 v56, v152, v153
    v_cvt_pk_bf16_f32 v57, v154, v155
    v_cvt_pk_bf16_f32 v58, v156, v157
    v_cvt_pk_bf16_f32 v59, v158, v159
    v_cvt_pk_bf16_f32 v60, v160, v161
    v_cvt_pk_bf16_f32 v61, v162, v163
    v_cvt_pk_bf16_f32 v62, v164, v165
    v_cvt_pk_bf16_f32 v63, v166, v167
    buffer_store_dwordx4 v[56:59], v5, s[28:31], s25 offen sc1
    buffer_store_dwordx4 v[60:63], v5, s[28:31], s25 offen offset:512 sc1
    s_add_u32 s25, s25, 0x20000
    v_cvt_pk_bf16_f32 v64, v168, v169
    v_cvt_pk_bf16_f32 v65, v170, v171
    v_cvt_pk_bf16_f32 v66, v172, v173
    v_cvt_pk_bf16_f32 v67, v174, v175
    v_cvt_pk_bf16_f32 v68, v176, v177
    v_cvt_pk_bf16_f32 v69, v178, v179
    v_cvt_pk_bf16_f32 v70, v180, v181
    v_cvt_pk_bf16_f32 v71, v182, v183
    buffer_store_dwordx4 v[64:67], v5, s[28:31], s25 offen sc1
    buffer_store_dwordx4 v[68:71], v5, s[28:31], s25 offen offset:512 sc1
    s_add_u32 s25, s25, 0x20000
    v_cvt_pk_bf16_f32 v72, v184, v185
    v_cvt_pk_bf16_f32 v73, v186, v187
    v_cvt_pk_bf16_f32 v74, v188, v189
    v_cvt_pk_bf16_f32 v75, v190, v191
    v_cvt_pk_bf16_f32 v76, v192, v193
    v_cvt_pk_bf16_f32 v77, v194, v195
    v_cvt_pk_bf16_f32 v78, v196, v197
    v_cvt_pk_bf16_f32 v79, v198, v199
    buffer_store_dwordx4 v[72:75], v5, s[28:31], s25 offen sc1
    buffer_store_dwordx4 v[76:79], v5, s[28:31], s25 offen offset:512 sc1
    s_add_u32 s25, s25, 0x20000
P2_CPUB:
    s_waitcnt vmcnt(0)
    v_mov_b32 v4, 24576
    v_mov_b32 v5, 1
    s_mov_b64 exec, 1
    ds_add_rtn_u32 v6, v4, v5
    s_mov_b64 exec, -1
    s_waitcnt lgkmcnt(0)
    v_readfirstlane_b32 s98, v6
    s_nop 1
    s_cmp_eq_u32 s98, 3
    s_cbranch_scc0 P2_PUB
    s_mul_i32 s22, s56, 12
    s_add_u32 s22, s22, s57
    s_add_u32 s22, s22, 384
    s_cmp_lg_u32 s88, 0
    s_cbranch_scc1 WPUB_11_OK
    s_mov_b32 s98, 0
WPUB_11_L:
    v_mov_b32 v250, 0
    global_load_dword v251, v250, s[84:85] sc1
    s_waitcnt vmcnt(0)
    v_readfirstlane_b32 s88, v251
    s_add_u32 s98, s98, 1
    s_cmp_gt_u32 s98, 0x4000
    s_cbranch_scc1 WPUB_11_OK
    s_cmp_eq_u32 s88, 0
    s_cbranch_scc1 WPUB_11_L
WPUB_11_OK:
    s_lshl_b32 s98, s22, 7
    v_mov_b32 v250, s98
    v_mov_b32 v251, s88
    s_mov_b64 exec, 1
    buffer_store_dword v251, v250, s[92:95], 0 offen sc1
    s_mov_b64 exec, -1
    s_branch P2_PUB
P2_HELP:
    s_branch P2_PUB
P2_UP:
    s_cmp_eq_u32 s91, 255
    s_cbranch_scc0 P2_MF_NO
    s_cmp_eq_u32 s89, 7
    s_cbranch_scc0 P2_MF_NO
    v_bfe_u32 v21, v2, 3, 2
    v_mul_u32_u24 v21, 48, v21
    v_and_b32 v22, 7, v2
    v_lshrrev_b32 v23, 5, v2
    v_mul_u32_u24 v23, 24, v23
    v_add3_u32 v21, v21, v22, v23
    v_add_u32 v21, 16, v21
    v_lshlrev_b32 v21, 7, v21
    s_mov_b32 s48, 0
P2_MF_P:
    buffer_load_dword v23, v21, s[92:95], 0 offen sc1
    s_add_u32 s48, s48, 1
    s_cmp_gt_u32 s48, 0x4000
    s_cbranch_scc1 P2_MF_G
    s_waitcnt vmcnt(0)
    v_cmp_ne_u32 vcc, s88, v23
    s_nop 1
    s_cmp_lg_u64 vcc, 0
    s_cbranch_scc1 P2_MF_P
P2_MF_G:
    s_mov_b32 s8, s86
    s_mov_b32 s9, s87
    s_mov_b32 s10, 0x10000
    s_mov_b32 s11, 0x20000
    v_lshlrev_b32 v20, 5, v2
    s_mov_b32 s47, 4096
    buffer_load_dwordx4 v[64:67], v20, s[8:11], s47 offen sc1
    buffer_load_dwordx4 v[68:71], v20, s[8:11], s47 offen offset:16 sc1
    s_mov_b32 s47, 16384
    buffer_load_dwordx4 v[72:75], v20, s[8:11], s47 offen sc1
    buffer_load_dwordx4 v[76:79], v20, s[8:11], s47 offen offset:16 sc1
    s_mov_b32 s47, 28672
    buffer_load_dwordx4 v[80:83], v20, s[8:11], s47 offen sc1
    buffer_load_dwordx4 v[84:87], v20, s[8:11], s47 offen offset:16 sc1
    s_mov_b32 s47, 40960
    buffer_load_dwordx4 v[88:91], v20, s[8:11], s47 offen sc1
    buffer_load_dwordx4 v[92:95], v20, s[8:11], s47 offen offset:16 sc1
    s_mov_b32 s47, 10240
    buffer_load_dwordx4 v[96:99], v20, s[8:11], s47 offen sc1
    buffer_load_dwordx4 v[100:103], v20, s[8:11], s47 offen offset:16 sc1
    s_mov_b32 s47, 22528
    buffer_load_dwordx4 v[104:107], v20, s[8:11], s47 offen sc1
    buffer_load_dwordx4 v[108:111], v20, s[8:11], s47 offen offset:16 sc1
    s_mov_b32 s47, 34816
    buffer_load_dwordx4 v[112:115], v20, s[8:11], s47 offen sc1
    buffer_load_dwordx4 v[116:119], v20, s[8:11], s47 offen offset:16 sc1
    s_mov_b32 s47, 47104
    buffer_load_dwordx4 v[120:123], v20, s[8:11], s47 offen sc1
    buffer_load_dwordx4 v[124:127], v20, s[8:11], s47 offen offset:16 sc1
    s_waitcnt vmcnt(0)
    v_add_f32 v64, v64, v72
    v_add_f32 v80, v80, v88
    v_add_f32 v65, v65, v73
    v_add_f32 v81, v81, v89
    v_add_f32 v66, v66, v74
    v_add_f32 v82, v82, v90
    v_add_f32 v67, v67, v75
    v_add_f32 v83, v83, v91
    v_add_f32 v68, v68, v76
    v_add_f32 v84, v84, v92
    v_add_f32 v69, v69, v77
    v_add_f32 v85, v85, v93
    v_add_f32 v70, v70, v78
    v_add_f32 v86, v86, v94
    v_add_f32 v71, v71, v79
    v_add_f32 v87, v87, v95
    v_add_f32 v64, v64, v80
    v_add_f32 v65, v65, v81
    v_add_f32 v66, v66, v82
    v_add_f32 v67, v67, v83
    v_add_f32 v68, v68, v84
    v_add_f32 v69, v69, v85
    v_add_f32 v70, v70, v86
    v_add_f32 v71, v71, v87
    v_cvt_pk_bf16_f32 v64, v64, v64
    v_cvt_pk_bf16_f32 v65, v65, v65
    v_cvt_pk_bf16_f32 v66, v66, v66
    v_cvt_pk_bf16_f32 v67, v67, v67
    v_cvt_pk_bf16_f32 v68, v68, v68
    v_cvt_pk_bf16_f32 v69, v69, v69
    v_cvt_pk_bf16_f32 v70, v70, v70
    v_cvt_pk_bf16_f32 v71, v71, v71
    v_lshlrev_b32 v64, 16, v64
    v_lshlrev_b32 v65, 16, v65
    v_lshlrev_b32 v66, 16, v66
    v_lshlrev_b32 v67, 16, v67
    v_lshlrev_b32 v68, 16, v68
    v_lshlrev_b32 v69, 16, v69
    v_lshlrev_b32 v70, 16, v70
    v_lshlrev_b32 v71, 16, v71
    s_mov_b32 s47, 49152
    buffer_store_dwordx4 v[64:67], v20, s[8:11], s47 offen sc1
    buffer_store_dwordx4 v[68:71], v20, s[8:11], s47 offen offset:16 sc1
    v_add_f32 v96, v96, v104
    v_add_f32 v112, v112, v120
    v_add_f32 v97, v97, v105
    v_add_f32 v113, v113, v121
    v_add_f32 v98, v98, v106
    v_add_f32 v114, v114, v122
    v_add_f32 v99, v99, v107
    v_add_f32 v115, v115, v123
    v_add_f32 v100, v100, v108
    v_add_f32 v116, v116, v124
    v_add_f32 v101, v101, v109
    v_add_f32 v117, v117, v125
    v_add_f32 v102, v102, v110
    v_add_f32 v118, v118, v126
    v_add_f32 v103, v103, v111
    v_add_f32 v119, v119, v127
    v_add_f32 v96, v96, v112
    v_add_f32 v97, v97, v113
    v_add_f32 v98, v98, v114
    v_add_f32 v99, v99, v115
    v_add_f32 v100, v100, v116
    v_add_f32 v101, v101, v117
    v_add_f32 v102, v102, v118
    v_add_f32 v103, v103, v119
    v_cvt_pk_bf16_f32 v96, v96, v96
    v_cvt_pk_bf16_f32 v97, v97, v97
    v_cvt_pk_bf16_f32 v98, v98, v98
    v_cvt_pk_bf16_f32 v99, v99, v99
    v_cvt_pk_bf16_f32 v100, v100, v100
    v_cvt_pk_bf16_f32 v101, v101, v101
    v_cvt_pk_bf16_f32 v102, v102, v102
    v_cvt_pk_bf16_f32 v103, v103, v103
    v_lshlrev_b32 v96, 16, v96
    v_lshlrev_b32 v97, 16, v97
    v_lshlrev_b32 v98, 16, v98
    v_lshlrev_b32 v99, 16, v99
    v_lshlrev_b32 v100, 16, v100
    v_lshlrev_b32 v101, 16, v101
    v_lshlrev_b32 v102, 16, v102
    v_lshlrev_b32 v103, 16, v103
    s_mov_b32 s47, 51200
    buffer_store_dwordx4 v[96:99], v20, s[8:11], s47 offen sc1
    buffer_store_dwordx4 v[100:103], v20, s[8:11], s47 offen offset:16 sc1
    s_waitcnt vmcnt(0)
    s_movk_i32 s47, 363
    s_cmp_lg_u32 s88, 0
    s_cbranch_scc1 WPUB_12_OK
    s_mov_b32 s98, 0
WPUB_12_L:
    v_mov_b32 v250, 0
    global_load_dword v251, v250, s[84:85] sc1
    s_waitcnt vmcnt(0)
    v_readfirstlane_b32 s88, v251
    s_add_u32 s98, s98, 1
    s_cmp_gt_u32 s98, 0x4000
    s_cbranch_scc1 WPUB_12_OK
    s_cmp_eq_u32 s88, 0
    s_cbranch_scc1 WPUB_12_L
WPUB_12_OK:
    s_lshl_b32 s98, s47, 7
    v_mov_b32 v250, s98
    v_mov_b32 v251, s88
    s_mov_b64 exec, 1
    buffer_store_dword v251, v250, s[92:95], 0 offen sc1
    s_mov_b64 exec, -1
P2_MF_NO:
    s_cmp_ge_u32 s89, 6
    s_cbranch_scc0 T2_END
    s_sub_u32 s25, s91, 192
    s_cmp_ge_u32 s25, 59
    s_cbranch_scc1 T2_END
    s_cmp_ge_u32 s25, 16
    s_cbranch_scc1 T2_W2
    s_mov_b32 s16, s68
    s_mov_b32 s17, s69
    s_mov_b32 s18, 0x80000
    s_mov_b32 s19, 0x20000
    s_add_u32 s28, s86, 0xd00000
    s_addc_u32 s29, s87, 0
    s_mov_b32 s30, 0x80000
    s_mov_b32 s31, 0x20000
    s_mov_b32 s32, 32768
    s_add_u32 s35, s25, 304
    s_branch T2_GO
T2_W2:
    s_sub_u32 s25, s25, 16
    s_mov_b32 s16, s76
    s_mov_b32 s17, s77
    s_mov_b32 s18, 0x158000
    s_mov_b32 s19, 0x20000
    s_add_u32 s28, s86, 0x1a00000
    s_addc_u32 s29, s87, 0
    s_mov_b32 s30, 0x158000
    s_mov_b32 s31, 0x20000
    s_mov_b32 s32, 88064
    s_add_u32 s35, s25, 320
T2_GO:
    v_and_b32 v8, 31, v2
    v_lshrrev_b32 v9, 5, v2
    v_lshlrev_b32 v10, 12, v9
    v_lshl_add_u32 v10, v8, 3, v10
    s_lshl_b32 s38, s25, 15
    s_sub_u32 s41, s89, 6
    s_lshl_b32 s39, s41, 9
    s_add_u32 s38, s38, s39
    s_add_u32 s39, s38, 0
    buffer_load_dwordx2 v[64:65], v10, s[16:19], s39 offen
    s_add_u32 s39, s38, 1024
    buffer_load_dwordx2 v[66:67], v10, s[16:19], s39 offen
    s_add_u32 s39, s38, 2048
    buffer_load_dwordx2 v[68:69], v10, s[16:19], s39 offen
    s_add_u32 s39, s38, 3072
    buffer_load_dwordx2 v[70:71], v10, s[16:19], s39 offen
    s_add_u32 s39, s38, 8192
    buffer_load_dwordx2 v[72:73], v10, s[16:19], s39 offen
    s_add_u32 s39, s38, 9216
    buffer_load_dwordx2 v[74:75], v10, s[16:19], s39 offen
    s_add_u32 s39, s38, 10240
    buffer_load_dwordx2 v[76:77], v10, s[16:19], s39 offen
    s_add_u32 s39, s38, 11264
    buffer_load_dwordx2 v[78:79], v10, s[16:19], s39 offen
    s_add_u32 s39, s38, 16384
    buffer_load_dwordx2 v[80:81], v10, s[16:19], s39 offen
    s_add_u32 s39, s38, 17408
    buffer_load_dwordx2 v[82:83], v10, s[16:19], s39 offen
    s_add_u32 s39, s38, 18432
    buffer_load_dwordx2 v[84:85], v10, s[16:19], s39 offen
    s_add_u32 s39, s38, 19456
    buffer_load_dwordx2 v[86:87], v10, s[16:19], s39 offen
    s_add_u32 s39, s38, 24576
    buffer_load_dwordx2 v[88:89], v10, s[16:19], s39 offen
    s_add_u32 s39, s38, 25600
    buffer_load_dwordx2 v[90:91], v10, s[16:19], s39 offen
    s_add_u32 s39, s38, 26624
    buffer_load_dwordx2 v[92:93], v10, s[16:19], s39 offen
    s_add_u32 s39, s38, 27648
    buffer_load_dwordx2 v[94:95], v10, s[16:19], s39 offen
    s_add_u32 s39, s38, 256
    buffer_load_dwordx2 v[96:97], v10, s[16:19], s39 offen
    s_add_u32 s39, s38, 1280
    buffer_load_dwordx2 v[98:99], v10, s[16:19], s39 offen
    s_add_u32 s39, s38, 2304
    buffer_load_dwordx2 v[100:101], v10, s[16:19], s39 offen
    s_add_u32 s39, s38, 3328
    buffer_load_dwordx2 v[102:103], v10, s[16:19], s39 offen
    s_add_u32 s39, s38, 8448
    buffer_load_dwordx2 v[104:105], v10, s[16:19], s39 offen
    s_add_u32 s39, s38, 9472
    buffer_load_dwordx2 v[106:107], v10, s[16:19], s39 offen
    s_add_u32 s39, s38, 10496
    buffer_load_dwordx2 v[108:109], v10, s[16:19], s39 offen
    s_add_u32 s39, s38, 11520
    buffer_load_dwordx2 v[110:111], v10, s[16:19], s39 offen
    s_add_u32 s39, s38, 16640
    buffer_load_dwordx2 v[112:113], v10, s[16:19], s39 offen
    s_add_u32 s39, s38, 17664
    buffer_load_dwordx2 v[114:115], v10, s[16:19], s39 offen
    s_add_u32 s39, s38, 18688
    buffer_load_dwordx2 v[116:117], v10, s[16:19], s39 offen
    s_add_u32 s39, s38, 19712
    buffer_load_dwordx2 v[118:119], v10, s[16:19], s39 offen
    s_add_u32 s39, s38, 24832
    buffer_load_dwordx2 v[120:121], v10, s[16:19], s39 offen
    s_add_u32 s39, s38, 25856
    buffer_load_dwordx2 v[122:123], v10, s[16:19], s39 offen
    s_add_u32 s39, s38, 26880
    buffer_load_dwordx2 v[124:125], v10, s[16:19], s39 offen
    s_add_u32 s39, s38, 27904
    buffer_load_dwordx2 v[126:127], v10, s[16:19], s39 offen
    v_lshrrev_b32 v11, 3, v8
    v_lshlrev_b32 v11, 10, v11
    v_and_b32 v12, 7, v8
    v_lshl_add_u32 v11, v12, 6, v11
    v_lshl_add_u32 v11, v9, 9, v11
    s_lshl_b32 s39, s41, 12
    s_add_u32 s39, s39, 98304
    v_add_u32 v11, s39, v11
    v_bfe_u32 v13, v8, 2, 1
    v_lshl_or_b32 v13, v9, 1, v13
    v_lshlrev_b32 v13, 4, v13
    v_bfe_u32 v14, v2, 4, 1
    v_lshrrev_b32 v15, 5, v2
    v_lshl_or_b32 v14, v15, 1, v14
    v_lshlrev_b32 v14, 4, v14
    v_xor_b32 v12, v14, v3
    v_add_u32 v12, s39, v12
    v_xor_b32 v16, 0, v13
    v_add_u32 v16, v16, v11
    v_xor_b32 v17, 16, v13
    v_add_u32 v17, v17, v11
    v_xor_b32 v18, 32, v13
    v_add_u32 v18, v18, v11
    v_xor_b32 v19, 48, v13
    v_add_u32 v19, v19, v11
    s_lshl_b32 s33, s25, 11
    s_lshl_b32 s40, s32, 3
    s_mul_i32 s40, s40, s41
    s_add_u32 s33, s33, s40
    s_mov_b32 s36, 0x05040100
    s_mov_b32 s37, 0x07060302
    s_waitcnt vmcnt(24)
    v_perm_b32 v48, v66, v64, s36
    v_perm_b32 v49, v70, v68, s36
    v_perm_b32 v50, v74, v72, s36
    v_perm_b32 v51, v78, v76, s36
    v_perm_b32 v52, v66, v64, s37
    v_perm_b32 v53, v70, v68, s37
    v_perm_b32 v54, v74, v72, s37
    v_perm_b32 v55, v78, v76, s37
    v_perm_b32 v56, v67, v65, s36
    v_perm_b32 v57, v71, v69, s36
    v_perm_b32 v58, v75, v73, s36
    v_perm_b32 v59, v79, v77, s36
    v_perm_b32 v60, v67, v65, s37
    v_perm_b32 v61, v71, v69, s37
    v_perm_b32 v62, v75, v73, s37
    v_perm_b32 v63, v79, v77, s37
    ds_write_b128 v16, v[48:51]
    ds_write_b128 v17, v[52:55]
    ds_write_b128 v18, v[56:59]
    ds_write_b128 v19, v[60:63]
    s_waitcnt lgkmcnt(0)
    ds_read_b128 v[128:131], v12 offset:0
    ds_read_b128 v[132:135], v12 offset:1024
    ds_read_b128 v[136:139], v12 offset:2048
    ds_read_b128 v[140:143], v12 offset:3072
    s_lshl_b32 s40, s32, 2
    s_mul_i32 s40, s40, 0
    s_add_u32 s40, s40, s33
    s_waitcnt lgkmcnt(3)
    buffer_store_dwordx4 v[128:131], v3, s[28:31], s40 offen offset:0 sc1
    s_add_u32 s40, s40, s32
    s_waitcnt lgkmcnt(2)
    buffer_store_dwordx4 v[132:135], v3, s[28:31], s40 offen offset:0 sc1
    s_add_u32 s40, s40, s32
    s_waitcnt lgkmcnt(1)
    buffer_store_dwordx4 v[136:139], v3, s[28:31], s40 offen offset:0 sc1
    s_add_u32 s40, s40, s32
    s_waitcnt lgkmcnt(0)
    buffer_store_dwordx4 v[140:143], v3, s[28:31], s40 offen offset:0 sc1
    s_waitcnt vmcnt(20)
    v_perm_b32 v48, v82, v80, s36
    v_perm_b32 v49, v86, v84, s36
    v_perm_b32 v50, v90, v88, s36
    v_perm_b32 v51, v94, v92, s36
    v_perm_b32 v52, v82, v80, s37
    v_perm_b32 v53, v86, v84, s37
    v_perm_b32 v54, v90, v88, s37
    v_perm_b32 v55, v94, v92, s37
    v_perm_b32 v56, v83, v81, s36
    v_perm_b32 v57, v87, v85, s36
    v_perm_b32 v58, v91, v89, s36
    v_perm_b32 v59, v95, v93, s36
    v_perm_b32 v60, v83, v81, s37
    v_perm_b32 v61, v87, v85, s37
    v_perm_b32 v62, v91, v89, s37
    v_perm_b32 v63, v95, v93, s37
    ds_write_b128 v16, v[48:51]
    ds_write_b128 v17, v[52:55]
    ds_write_b128 v18, v[56:59]
    ds_write_b128 v19, v[60:63]
    s_waitcnt lgkmcnt(0)
    ds_read_b128 v[144:147], v12 offset:0
    ds_read_b128 v[148:151], v12 offset:1024
    ds_read_b128 v[152:155], v12 offset:2048
    ds_read_b128 v[156:159], v12 offset:3072
    s_lshl_b32 s40, s32, 2
    s_mul_i32 s40, s40, 0
    s_add_u32 s40, s40, s33
    s_waitcnt lgkmcnt(3)
    buffer_store_dwordx4 v[144:147], v3, s[28:31], s40 offen offset:1024 sc1
    s_add_u32 s40, s40, s32
    s_waitcnt lgkmcnt(2)
    buffer_store_dwordx4 v[148:151], v3, s[28:31], s40 offen offset:1024 sc1
    s_add_u32 s40, s40, s32
    s_waitcnt lgkmcnt(1)
    buffer_store_dwordx4 v[152:155], v3, s[28:31], s40 offen offset:1024 sc1
    s_add_u32 s40, s40, s32
    s_waitcnt lgkmcnt(0)
    buffer_store_dwordx4 v[156:159], v3, s[28:31], s40 offen offset:1024 sc1
    s_waitcnt vmcnt(16)
    v_perm_b32 v48, v98, v96, s36
    v_perm_b32 v49, v102, v100, s36
    v_perm_b32 v50, v106, v104, s36
    v_perm_b32 v51, v110, v108, s36
    v_perm_b32 v52, v98, v96, s37
    v_perm_b32 v53, v102, v100, s37
    v_perm_b32 v54, v106, v104, s37
    v_perm_b32 v55, v110, v108, s37
    v_perm_b32 v56, v99, v97, s36
    v_perm_b32 v57, v103, v101, s36
    v_perm_b32 v58, v107, v105, s36
    v_perm_b32 v59, v111, v109, s36
    v_perm_b32 v60, v99, v97, s37
    v_perm_b32 v61, v103, v101, s37
    v_perm_b32 v62, v107, v105, s37
    v_perm_b32 v63, v111, v109, s37
    ds_write_b128 v16, v[48:51]
    ds_write_b128 v17, v[52:55]
    ds_write_b128 v18, v[56:59]
    ds_write_b128 v19, v[60:63]
    s_waitcnt lgkmcnt(0)
    ds_read_b128 v[160:163], v12 offset:0
    ds_read_b128 v[164:167], v12 offset:1024
    ds_read_b128 v[168:171], v12 offset:2048
    ds_read_b128 v[172:175], v12 offset:3072
    s_lshl_b32 s40, s32, 2
    s_mul_i32 s40, s40, 1
    s_add_u32 s40, s40, s33
    s_waitcnt lgkmcnt(3)
    buffer_store_dwordx4 v[160:163], v3, s[28:31], s40 offen offset:0 sc1
    s_add_u32 s40, s40, s32
    s_waitcnt lgkmcnt(2)
    buffer_store_dwordx4 v[164:167], v3, s[28:31], s40 offen offset:0 sc1
    s_add_u32 s40, s40, s32
    s_waitcnt lgkmcnt(1)
    buffer_store_dwordx4 v[168:171], v3, s[28:31], s40 offen offset:0 sc1
    s_add_u32 s40, s40, s32
    s_waitcnt lgkmcnt(0)
    buffer_store_dwordx4 v[172:175], v3, s[28:31], s40 offen offset:0 sc1
    s_waitcnt vmcnt(12)
    v_perm_b32 v48, v114, v112, s36
    v_perm_b32 v49, v118, v116, s36
    v_perm_b32 v50, v122, v120, s36
    v_perm_b32 v51, v126, v124, s36
    v_perm_b32 v52, v114, v112, s37
    v_perm_b32 v53, v118, v116, s37
    v_perm_b32 v54, v122, v120, s37
    v_perm_b32 v55, v126, v124, s37
    v_perm_b32 v56, v115, v113, s36
    v_perm_b32 v57, v119, v117, s36
    v_perm_b32 v58, v123, v121, s36
    v_perm_b32 v59, v127, v125, s36
    v_perm_b32 v60, v115, v113, s37
    v_perm_b32 v61, v119, v117, s37
    v_perm_b32 v62, v123, v121, s37
    v_perm_b32 v63, v127, v125, s37
    ds_write_b128 v16, v[48:51]
    ds_write_b128 v17, v[52:55]
    ds_write_b128 v18, v[56:59]
    ds_write_b128 v19, v[60:63]
    s_waitcnt lgkmcnt(0)
    ds_read_b128 v[176:179], v12 offset:0
    ds_read_b128 v[180:183], v12 offset:1024
    ds_read_b128 v[184:187], v12 offset:2048
    ds_read_b128 v[188:191], v12 offset:3072
    s_lshl_b32 s40, s32, 2
    s_mul_i32 s40, s40, 1
    s_add_u32 s40, s40, s33
    s_waitcnt lgkmcnt(3)
    buffer_store_dwordx4 v[176:179], v3, s[28:31], s40 offen offset:1024 sc1
    s_add_u32 s40, s40, s32
    s_waitcnt lgkmcnt(2)
    buffer_store_dwordx4 v[180:183], v3, s[28:31], s40 offen offset:1024 sc1
    s_add_u32 s40, s40, s32
    s_waitcnt lgkmcnt(1)
    buffer_store_dwordx4 v[184:187], v3, s[28:31], s40 offen offset:1024 sc1
    s_add_u32 s40, s40, s32
    s_waitcnt lgkmcnt(0)
    buffer_store_dwordx4 v[188:191], v3, s[28:31], s40 offen offset:1024 sc1
    s_waitcnt vmcnt(0)
    v_mov_b32 v4, 106496
    v_mov_b32 v5, s88
    s_mov_b64 exec, 1
    ds_wrxchg_rtn_b32 v6, v4, v5
    s_mov_b64 exec, -1
    s_waitcnt lgkmcnt(0)
    v_readfirstlane_b32 s98, v6
    s_nop 1
    s_cmp_eq_u32 s98, s88
    s_cbranch_scc0 T2_END
    s_cmp_lg_u32 s88, 0
    s_cbranch_scc1 WPUB_13_OK
    s_mov_b32 s98, 0
WPUB_13_L:
    v_mov_b32 v250, 0
    global_load_dword v251, v250, s[84:85] sc1
    s_waitcnt vmcnt(0)
    v_readfirstlane_b32 s88, v251
    s_add_u32 s98, s98, 1
    s_cmp_gt_u32 s98, 0x4000
    s_cbranch_scc1 WPUB_13_OK
    s_cmp_eq_u32 s88, 0
    s_cbranch_scc1 WPUB_13_L
WPUB_13_OK:
    s_lshl_b32 s98, s35, 7
    v_mov_b32 v250, s98
    v_mov_b32 v251, s88
    s_mov_b64 exec, 1
    buffer_store_dword v251, v250, s[92:95], 0 offen sc1
    s_mov_b64 exec, -1
T2_END:
    s_cmp_ge_u32 s40, 352
    s_cbranch_scc1 UP_END
    v_mov_b32 v20, 0
    v_lshrrev_b32 v21, 4, v2
    v_mul_u32_u24 v21, 48, v21
    v_and_b32 v22, 15, v2
    v_add3_u32 v21, v21, v22, 24
    v_lshlrev_b32 v21, 7, v21
    s_mov_b32 s48, 0
UP_POLL:
    buffer_load_dword v23, v21, s[92:95], 0 offen sc1
    s_add_u32 s48, s48, 1
    s_cmp_gt_u32 s48, 0x4000
    s_cbranch_scc1 UP_GO
    s_waitcnt vmcnt(0)
    v_cmp_ne_u32 vcc, s88, v23
    s_nop 1
    s_cmp_lg_u64 vcc, 0
    s_cbranch_scc1 UP_POLL
UP_GO:
    s_mov_b32 s8, s86
    s_mov_b32 s9, s87
    s_mov_b32 s10, 0x10000
    s_mov_b32 s11, 0x20000
    v_lshlrev_b32 v15, 2, v227
    s_lshl_b32 s46, s45, 2
    s_add_u32 s47, s46, 6144
    buffer_load_dwordx4 v[96:99], v15, s[8:11], s47 offen sc1
    buffer_load_dwordx4 v[100:103], v15, s[8:11], s47 offen offset:32 sc1
    s_add_u32 s47, s46, 18432
    buffer_load_dwordx4 v[104:107], v15, s[8:11], s47 offen sc1
    buffer_load_dwordx4 v[108:111], v15, s[8:11], s47 offen offset:32 sc1
    s_add_u32 s47, s46, 30720
    buffer_load_dwordx4 v[112:115], v15, s[8:11], s47 offen sc1
    buffer_load_dwordx4 v[116:119], v15, s[8:11], s47 offen offset:32 sc1
    s_add_u32 s47, s46, 43008
    buffer_load_dwordx4 v[120:123], v15, s[8:11], s47 offen sc1
    buffer_load_dwordx4 v[124:127], v15, s[8:11], s47 offen offset:32 sc1
    s_add_u32 s47, s46, 8192
    buffer_load_dwordx4 v[128:131], v15, s[8:11], s47 offen sc1
    buffer_load_dwordx4 v[132:135], v15, s[8:11], s47 offen offset:32 sc1
    s_add_u32 s47, s46, 20480
    buffer_load_dwordx4 v[136:139], v15, s[8:11], s47 offen sc1
    buffer_load_dwordx4 v[140:143], v15, s[8:11], s47 offen offset:32 sc1
    s_add_u32 s47, s46, 32768
    buffer_load_dwordx4 v[144:147], v15, s[8:11], s47 offen sc1
    buffer_load_dwordx4 v[148:151], v15, s[8:11], s47 offen offset:32 sc1
    s_add_u32 s47, s46, 45056
    buffer_load_dwordx4 v[152:155], v15, s[8:11], s47 offen sc1
    buffer_load_dwordx4 v[156:159], v15, s[8:11], s47 offen offset:32 sc1
    s_waitcnt vmcnt(0)
    v_add_f32 v96, v96, v104
    v_add_f32 v112, v112, v120
    v_add_f32 v97, v97, v105
    v_add_f32 v113, v113, v121
    v_add_f32 v98, v98, v106
    v_add_f32 v114, v114, v122
    v_add_f32 v99, v99, v107
    v_add_f32 v115, v115, v123
    v_add_f32 v100, v100, v108
    v_add_f32 v116, v116, v124
    v_add_f32 v101, v101, v109
    v_add_f32 v117, v117, v125
    v_add_f32 v102, v102, v110
    v_add_f32 v118, v118, v126
    v_add_f32 v103, v103, v111
    v_add_f32 v119, v119, v127
    v_add_f32 v96, v96, v112
    v_add_f32 v97, v97, v113
    v_add_f32 v98, v98, v114
    v_add_f32 v99, v99, v115
    v_add_f32 v100, v100, v116
    v_add_f32 v101, v101, v117
    v_add_f32 v102, v102, v118
    v_add_f32 v103, v103, v119
    v_cvt_pk_bf16_f32 v96, v96, v96
    v_cvt_pk_bf16_f32 v97, v97, v97
    v_cvt_pk_bf16_f32 v98, v98, v98
    v_cvt_pk_bf16_f32 v99, v99, v99
    v_cvt_pk_bf16_f32 v100, v100, v100
    v_cvt_pk_bf16_f32 v101, v101, v101
    v_cvt_pk_bf16_f32 v102, v102, v102
    v_cvt_pk_bf16_f32 v103, v103, v103
    v_lshlrev_b32 v32, 16, v96
    v_lshlrev_b32 v33, 16, v97
    v_lshlrev_b32 v34, 16, v98
    v_lshlrev_b32 v35, 16, v99
    v_lshlrev_b32 v36, 16, v100
    v_lshlrev_b32 v37, 16, v101
    v_lshlrev_b32 v38, 16, v102
    v_lshlrev_b32 v39, 16, v103
    v_add_f32 v128, v128, v136
    v_add_f32 v144, v144, v152
    v_add_f32 v129, v129, v137
    v_add_f32 v145, v145, v153
    v_add_f32 v130, v130, v138
    v_add_f32 v146, v146, v154
    v_add_f32 v131, v131, v139
    v_add_f32 v147, v147, v155
    v_add_f32 v132, v132, v140
    v_add_f32 v148, v148, v156
    v_add_f32 v133, v133, v141
    v_add_f32 v149, v149, v157
    v_add_f32 v134, v134, v142
    v_add_f32 v150, v150, v158
    v_add_f32 v135, v135, v143
    v_add_f32 v151, v151, v159
    v_add_f32 v128, v128, v144
    v_add_f32 v129, v129, v145
    v_add_f32 v130, v130, v146
    v_add_f32 v131, v131, v147
    v_add_f32 v132, v132, v148
    v_add_f32 v133, v133, v149
    v_add_f32 v134, v134, v150
    v_add_f32 v135, v135, v151
    v_cvt_pk_bf16_f32 v128, v128, v128
    v_cvt_pk_bf16_f32 v129, v129, v129
    v_cvt_pk_bf16_f32 v130, v130, v130
    v_cvt_pk_bf16_f32 v131, v131, v131
    v_cvt_pk_bf16_f32 v132, v132, v132
    v_cvt_pk_bf16_f32 v133, v133, v133
    v_cvt_pk_bf16_f32 v134, v134, v134
    v_cvt_pk_bf16_f32 v135, v135, v135
    v_lshlrev_b32 v40, 16, v128
    v_lshlrev_b32 v41, 16, v129
    v_lshlrev_b32 v42, 16, v130
    v_lshlrev_b32 v43, 16, v131
    v_lshlrev_b32 v44, 16, v132
    v_lshlrev_b32 v45, 16, v133
    v_lshlrev_b32 v46, 16, v134
    v_lshlrev_b32 v47, 16, v135
    v_add_f32 v40, 1.0, v40
    v_add_f32 v41, 1.0, v41
    v_add_f32 v42, 1.0, v42
    v_add_f32 v43, 1.0, v43
    v_add_f32 v44, 1.0, v44
    v_add_f32 v45, 1.0, v45
    v_add_f32 v46, 1.0, v46
    v_add_f32 v47, 1.0, v47
    v_cvt_pk_bf16_f32 v40, v40, v40
    v_cvt_pk_bf16_f32 v41, v41, v41
    v_cvt_pk_bf16_f32 v42, v42, v42
    v_cvt_pk_bf16_f32 v43, v43, v43
    v_cvt_pk_bf16_f32 v44, v44, v44
    v_cvt_pk_bf16_f32 v45, v45, v45
    v_cvt_pk_bf16_f32 v46, v46, v46
    v_cvt_pk_bf16_f32 v47, v47, v47
    v_lshlrev_b32 v40, 16, v40
    v_lshlrev_b32 v41, 16, v41
    v_lshlrev_b32 v42, 16, v42
    v_lshlrev_b32 v43, 16, v43
    v_lshlrev_b32 v44, 16, v44
    v_lshlrev_b32 v45, 16, v45
    v_lshlrev_b32 v46, 16, v46
    v_lshlrev_b32 v47, 16, v47
    s_add_u32 s28, s86, 0x1100000
    s_addc_u32 s29, s87, 0
    s_mov_b32 s30, 0x2c5800
    s_mov_b32 s31, 0x20000
    v_lshrrev_b32 v16, 1, v224
    v_and_b32 v17, 1, v16
    v_lshl_or_b32 v17, v17, 2, v226
    v_lshlrev_b32 v17, 4, v17
    v_and_b32 v16, 1, v16
    v_lshlrev_b32 v16, 11, v16
    v_lshl_add_u32 v16, v226, 9, v16
    v_lshl_add_u32 v16, v225, 8, v16
    v_and_b32 v18, 1, v224
    v_lshl_add_u32 v16, v18, 7, v16
    s_lshl_b32 s46, s89, 12
    s_add_u32 s46, s46, 32768
    v_add_u32 v16, s46, v16
    v_lshlrev_b32 v96, 16, v192
    v_and_b32 v97, 0xffff0000, v192
    v_lshlrev_b32 v98, 16, v193
    v_and_b32 v99, 0xffff0000, v193
    v_lshlrev_b32 v100, 16, v194
    v_and_b32 v101, 0xffff0000, v194
    v_lshlrev_b32 v102, 16, v195
    v_and_b32 v103, 0xffff0000, v195
    v_lshlrev_b32 v104, 16, v196
    v_and_b32 v105, 0xffff0000, v196
    v_lshlrev_b32 v106, 16, v197
    v_and_b32 v107, 0xffff0000, v197
    v_lshlrev_b32 v108, 16, v198
    v_and_b32 v109, 0xffff0000, v198
    v_lshlrev_b32 v110, 16, v199
    v_and_b32 v111, 0xffff0000, v199
    v_lshlrev_b32 v112, 16, v200
    v_and_b32 v113, 0xffff0000, v200
    v_lshlrev_b32 v114, 16, v201
    v_and_b32 v115, 0xffff0000, v201
    v_lshlrev_b32 v116, 16, v202
    v_and_b32 v117, 0xffff0000, v202
    v_lshlrev_b32 v118, 16, v203
    v_and_b32 v119, 0xffff0000, v203
    v_lshlrev_b32 v120, 16, v204
    v_and_b32 v121, 0xffff0000, v204
    v_lshlrev_b32 v122, 16, v205
    v_and_b32 v123, 0xffff0000, v205
    v_lshlrev_b32 v124, 16, v206
    v_and_b32 v125, 0xffff0000, v206
    v_lshlrev_b32 v126, 16, v207
    v_and_b32 v127, 0xffff0000, v207
    v_lshlrev_b32 v128, 16, v208
    v_and_b32 v129, 0xffff0000, v208
    v_lshlrev_b32 v130, 16, v209
    v_and_b32 v131, 0xffff0000, v209
    v_lshlrev_b32 v132, 16, v210
    v_and_b32 v133, 0xffff0000, v210
    v_lshlrev_b32 v134, 16, v211
    v_and_b32 v135, 0xffff0000, v211
    v_lshlrev_b32 v136, 16, v212
    v_and_b32 v137, 0xffff0000, v212
    v_lshlrev_b32 v138, 16, v213
    v_and_b32 v139, 0xffff0000, v213
    v_lshlrev_b32 v140, 16, v214
    v_and_b32 v141, 0xffff0000, v214
    v_lshlrev_b32 v142, 16, v215
    v_and_b32 v143, 0xffff0000, v215
    v_lshlrev_b32 v144, 16, v216
    v_and_b32 v145, 0xffff0000, v216
    v_lshlrev_b32 v146, 16, v217
    v_and_b32 v147, 0xffff0000, v217
    v_lshlrev_b32 v148, 16, v218
    v_and_b32 v149, 0xffff0000, v218
    v_lshlrev_b32 v150, 16, v219
    v_and_b32 v151, 0xffff0000, v219
    v_lshlrev_b32 v152, 16, v220
    v_and_b32 v153, 0xffff0000, v220
    v_lshlrev_b32 v154, 16, v221
    v_and_b32 v155, 0xffff0000, v221
    v_lshlrev_b32 v156, 16, v222
    v_and_b32 v157, 0xffff0000, v222
    v_lshlrev_b32 v158, 16, v223
    v_and_b32 v159, 0xffff0000, v223
    v_pk_mul_f32 v[48:49], v[96:97], v[32:33] op_sel_hi:[1,0]
    v_pk_mul_f32 v[50:51], v[98:99], v[32:33] op_sel_hi:[1,0]
    v_pk_mul_f32 v[52:53], v[100:101], v[32:33] op_sel_hi:[1,0]
    v_pk_mul_f32 v[54:55], v[102:103], v[32:33] op_sel_hi:[1,0]
    v_pk_fma_f32 v[48:49], v[104:105], v[32:33], v[48:49] op_sel:[0,1,0] op_sel_hi:[1,1,1]
    v_pk_fma_f32 v[50:51], v[106:107], v[32:33], v[50:51] op_sel:[0,1,0] op_sel_hi:[1,1,1]
    v_pk_fma_f32 v[52:53], v[108:109], v[32:33], v[52:53] op_sel:[0,1,0] op_sel_hi:[1,1,1]
    v_pk_fma_f32 v[54:55], v[110:111], v[32:33], v[54:55] op_sel:[0,1,0] op_sel_hi:[1,1,1]
    v_pk_fma_f32 v[48:49], v[112:113], v[34:35], v[48:49] op_sel_hi:[1,0,1]
    v_pk_fma_f32 v[50:51], v[114:115], v[34:35], v[50:51] op_sel_hi:[1,0,1]
    v_pk_fma_f32 v[52:53], v[116:117], v[34:35], v[52:53] op_sel_hi:[1,0,1]
    v_pk_fma_f32 v[54:55], v[118:119], v[34:35], v[54:55] op_sel_hi:[1,0,1]
    v_pk_fma_f32 v[48:49], v[120:121], v[34:35], v[48:49] op_sel:[0,1,0] op_sel_hi:[1,1,1]
    v_pk_fma_f32 v[50:51], v[122:123], v[34:35], v[50:51] op_sel:[0,1,0] op_sel_hi:[1,1,1]
    v_pk_fma_f32 v[52:53], v[124:125], v[34:35], v[52:53] op_sel:[0,1,0] op_sel_hi:[1,1,1]
    v_pk_fma_f32 v[54:55], v[126:127], v[34:35], v[54:55] op_sel:[0,1,0] op_sel_hi:[1,1,1]
    v_pk_fma_f32 v[48:49], v[128:129], v[36:37], v[48:49] op_sel_hi:[1,0,1]
    v_pk_fma_f32 v[50:51], v[130:131], v[36:37], v[50:51] op_sel_hi:[1,0,1]
    v_pk_fma_f32 v[52:53], v[132:133], v[36:37], v[52:53] op_sel_hi:[1,0,1]
    v_pk_fma_f32 v[54:55], v[134:135], v[36:37], v[54:55] op_sel_hi:[1,0,1]
    v_pk_fma_f32 v[48:49], v[136:137], v[36:37], v[48:49] op_sel:[0,1,0] op_sel_hi:[1,1,1]
    v_pk_fma_f32 v[50:51], v[138:139], v[36:37], v[50:51] op_sel:[0,1,0] op_sel_hi:[1,1,1]
    v_pk_fma_f32 v[52:53], v[140:141], v[36:37], v[52:53] op_sel:[0,1,0] op_sel_hi:[1,1,1]
    v_pk_fma_f32 v[54:55], v[142:143], v[36:37], v[54:55] op_sel:[0,1,0] op_sel_hi:[1,1,1]
    v_pk_fma_f32 v[48:49], v[144:145], v[38:39], v[48:49] op_sel_hi:[1,0,1]
    v_pk_fma_f32 v[50:51], v[146:147], v[38:39], v[50:51] op_sel_hi:[1,0,1]
    v_pk_fma_f32 v[52:53], v[148:149], v[38:39], v[52:53] op_sel_hi:[1,0,1]
    v_pk_fma_f32 v[54:55], v[150:151], v[38:39], v[54:55] op_sel_hi:[1,0,1]
    v_pk_fma_f32 v[48:49], v[152:153], v[38:39], v[48:49] op_sel:[0,1,0] op_sel_hi:[1,1,1]
    v_pk_fma_f32 v[50:51], v[154:155], v[38:39], v[50:51] op_sel:[0,1,0] op_sel_hi:[1,1,1]
    v_pk_fma_f32 v[52:53], v[156:157], v[38:39], v[52:53] op_sel:[0,1,0] op_sel_hi:[1,1,1]
    v_pk_fma_f32 v[54:55], v[158:159], v[38:39], v[54:55] op_sel:[0,1,0] op_sel_hi:[1,1,1]
    v_pk_mul_f32 v[96:97], v[96:97], v[40:41] op_sel_hi:[1,0]
    v_pk_mul_f32 v[98:99], v[98:99], v[40:41] op_sel_hi:[1,0]
    v_pk_mul_f32 v[100:101], v[100:101], v[40:41] op_sel_hi:[1,0]
    v_pk_mul_f32 v[102:103], v[102:103], v[40:41] op_sel_hi:[1,0]
    v_pk_mul_f32 v[104:105], v[104:105], v[40:41] op_sel:[0,1] op_sel_hi:[1,1]
    v_pk_mul_f32 v[106:107], v[106:107], v[40:41] op_sel:[0,1] op_sel_hi:[1,1]
    v_pk_mul_f32 v[108:109], v[108:109], v[40:41] op_sel:[0,1] op_sel_hi:[1,1]
    v_pk_mul_f32 v[110:111], v[110:111], v[40:41] op_sel:[0,1] op_sel_hi:[1,1]
    v_pk_mul_f32 v[112:113], v[112:113], v[42:43] op_sel_hi:[1,0]
    v_pk_mul_f32 v[114:115], v[114:115], v[42:43] op_sel_hi:[1,0]
    v_pk_mul_f32 v[116:117], v[116:117], v[42:43] op_sel_hi:[1,0]
    v_pk_mul_f32 v[118:119], v[118:119], v[42:43] op_sel_hi:[1,0]
    v_pk_mul_f32 v[120:121], v[120:121], v[42:43] op_sel:[0,1] op_sel_hi:[1,1]
    v_pk_mul_f32 v[122:123], v[122:123], v[42:43] op_sel:[0,1] op_sel_hi:[1,1]
    v_pk_mul_f32 v[124:125], v[124:125], v[42:43] op_sel:[0,1] op_sel_hi:[1,1]
    v_pk_mul_f32 v[126:127], v[126:127], v[42:43] op_sel:[0,1] op_sel_hi:[1,1]
    v_pk_mul_f32 v[128:129], v[128:129], v[44:45] op_sel_hi:[1,0]
    v_pk_mul_f32 v[130:131], v[130:131], v[44:45] op_sel_hi:[1,0]
    v_pk_mul_f32 v[132:133], v[132:133], v[44:45] op_sel_hi:[1,0]
    v_pk_mul_f32 v[134:135], v[134:135], v[44:45] op_sel_hi:[1,0]
    v_pk_mul_f32 v[136:137], v[136:137], v[44:45] op_sel:[0,1] op_sel_hi:[1,1]
    v_pk_mul_f32 v[138:139], v[138:139], v[44:45] op_sel:[0,1] op_sel_hi:[1,1]
    v_pk_mul_f32 v[140:141], v[140:141], v[44:45] op_sel:[0,1] op_sel_hi:[1,1]
    v_pk_mul_f32 v[142:143], v[142:143], v[44:45] op_sel:[0,1] op_sel_hi:[1,1]
    v_pk_mul_f32 v[144:145], v[144:145], v[46:47] op_sel_hi:[1,0]
    v_pk_mul_f32 v[146:147], v[146:147], v[46:47] op_sel_hi:[1,0]
    v_pk_mul_f32 v[148:149], v[148:149], v[46:47] op_sel_hi:[1,0]
    v_pk_mul_f32 v[150:151], v[150:151], v[46:47] op_sel_hi:[1,0]
    v_pk_mul_f32 v[152:153], v[152:153], v[46:47] op_sel:[0,1] op_sel_hi:[1,1]
    v_pk_mul_f32 v[154:155], v[154:155], v[46:47] op_sel:[0,1] op_sel_hi:[1,1]
    v_pk_mul_f32 v[156:157], v[156:157], v[46:47] op_sel:[0,1] op_sel_hi:[1,1]
    v_pk_mul_f32 v[158:159], v[158:159], v[46:47] op_sel:[0,1] op_sel_hi:[1,1]
    v_cvt_pk_bf16_f32 v160, v96, v104
    v_cvt_pk_bf16_f32 v161, v112, v120
    v_cvt_pk_bf16_f32 v162, v128, v136
    v_cvt_pk_bf16_f32 v163, v144, v152
    v_cvt_pk_bf16_f32 v164, v97, v105
    v_cvt_pk_bf16_f32 v165, v113, v121
    v_cvt_pk_bf16_f32 v166, v129, v137
    v_cvt_pk_bf16_f32 v167, v145, v153
    v_cvt_pk_bf16_f32 v168, v98, v106
    v_cvt_pk_bf16_f32 v169, v114, v122
    v_cvt_pk_bf16_f32 v170, v130, v138
    v_cvt_pk_bf16_f32 v171, v146, v154
    v_cvt_pk_bf16_f32 v172, v99, v107
    v_cvt_pk_bf16_f32 v173, v115, v123
    v_cvt_pk_bf16_f32 v174, v131, v139
    v_cvt_pk_bf16_f32 v175, v147, v155
    v_cvt_pk_bf16_f32 v176, v100, v108
    v_cvt_pk_bf16_f32 v177, v116, v124
    v_cvt_pk_bf16_f32 v178, v132, v140
    v_cvt_pk_bf16_f32 v179, v148, v156
    v_cvt_pk_bf16_f32 v180, v101, v109
    v_cvt_pk_bf16_f32 v181, v117, v125
    v_cvt_pk_bf16_f32 v182, v133, v141
    v_cvt_pk_bf16_f32 v183, v149, v157
    v_cvt_pk_bf16_f32 v184, v102, v110
    v_cvt_pk_bf16_f32 v185, v118, v126
    v_cvt_pk_bf16_f32 v186, v134, v142
    v_cvt_pk_bf16_f32 v187, v150, v158
    v_cvt_pk_bf16_f32 v188, v103, v111
    v_cvt_pk_bf16_f32 v189, v119, v127
    v_cvt_pk_bf16_f32 v190, v135, v143
    v_cvt_pk_bf16_f32 v191, v151, v159
    s_mov_b32 s47, 0x3f803f80
    v_dot2_f32_bf16 v56, v160, s47, 0
    v_dot2_f32_bf16 v57, v164, s47, 0
    v_dot2_f32_bf16 v58, v168, s47, 0
    v_dot2_f32_bf16 v59, v172, s47, 0
    v_dot2_f32_bf16 v60, v176, s47, 0
    v_dot2_f32_bf16 v61, v180, s47, 0
    v_dot2_f32_bf16 v62, v184, s47, 0
    v_dot2_f32_bf16 v63, v188, s47, 0
    v_dot2_f32_bf16 v56, v161, s47, v56
    v_dot2_f32_bf16 v57, v165, s47, v57
    v_dot2_f32_bf16 v58, v169, s47, v58
    v_dot2_f32_bf16 v59, v173, s47, v59
    v_dot2_f32_bf16 v60, v177, s47, v60
    v_dot2_f32_bf16 v61, v181, s47, v61
    v_dot2_f32_bf16 v62, v185, s47, v62
    v_dot2_f32_bf16 v63, v189, s47, v63
    v_dot2_f32_bf16 v56, v162, s47, v56
    v_dot2_f32_bf16 v57, v166, s47, v57
    v_dot2_f32_bf16 v58, v170, s47, v58
    v_dot2_f32_bf16 v59, v174, s47, v59
    v_dot2_f32_bf16 v60, v178, s47, v60
    v_dot2_f32_bf16 v61, v182, s47, v61
    v_dot2_f32_bf16 v62, v186, s47, v62
    v_dot2_f32_bf16 v63, v190, s47, v63
    v_dot2_f32_bf16 v56, v163, s47, v56
    v_dot2_f32_bf16 v57, v167, s47, v57
    v_dot2_f32_bf16 v58, v171, s47, v58
    v_dot2_f32_bf16 v59, v175, s47, v59
    v_dot2_f32_bf16 v60, v179, s47, v60
    v_dot2_f32_bf16 v61, v183, s47, v61
    v_dot2_f32_bf16 v62, v187, s47, v62
    v_dot2_f32_bf16 v63, v191, s47, v63
    v_lshrrev_b32 v18, 5, v2
    v_and_b32 v19, 15, v2
    v_bfe_u32 v24, v2, 4, 1
    v_lshlrev_b32 v24, 8, v24
    v_lshl_add_u32 v24, v18, 9, v24
    v_add_u32 v24, s46, v24
    v_xor_b32 v200, 0, v17
    v_add_u32 v200, v200, v16
    v_xor_b32 v201, 16, v17
    v_add_u32 v201, v201, v16
    v_xor_b32 v202, 32, v17
    v_add_u32 v202, v202, v16
    v_xor_b32 v203, 48, v17
    v_add_u32 v203, v203, v16
    v_xor_b32 v204, 64, v17
    v_add_u32 v204, v204, v16
    v_xor_b32 v205, 80, v17
    v_add_u32 v205, v205, v16
    v_xor_b32 v206, 96, v17
    v_add_u32 v206, v206, v16
    v_xor_b32 v207, 112, v17
    v_add_u32 v207, v207, v16
    v_cmp_gt_u32 vcc, 4, v224
    s_nop 1
    s_mov_b64 s[48:49], vcc
    s_mov_b64 exec, s[48:49]
    ds_write_b128 v200, v[160:163]
    ds_write_b128 v201, v[164:167]
    ds_write_b128 v202, v[168:171]
    ds_write_b128 v203, v[172:175]
    ds_write_b128 v204, v[176:179]
    ds_write_b128 v205, v[180:183]
    ds_write_b128 v206, v[184:187]
    ds_write_b128 v207, v[188:191]
    s_mov_b64 exec, -1
    s_waitcnt lgkmcnt(0)
    v_or_b32 v25, 0, v18
    v_xor_b32 v25, v25, v19
    v_lshl_add_u32 v25, v25, 4, v24
    ds_read_b128 v[96:99], v25 offset:0
    v_or_b32 v25, 2, v18
    v_xor_b32 v25, v25, v19
    v_lshl_add_u32 v25, v25, 4, v24
    ds_read_b128 v[100:103], v25 offset:1024
    v_or_b32 v25, 4, v18
    v_xor_b32 v25, v25, v19
    v_lshl_add_u32 v25, v25, 4, v24
    ds_read_b128 v[104:107], v25 offset:2048
    v_or_b32 v25, 6, v18
    v_xor_b32 v25, v25, v19
    v_lshl_add_u32 v25, v25, 4, v24
    ds_read_b128 v[108:111], v25 offset:3072
    s_waitcnt lgkmcnt(0)
    s_andn2_b64 exec, -1, s[48:49]
    ds_write_b128 v200, v[160:163]
    ds_write_b128 v201, v[164:167]
    ds_write_b128 v202, v[168:171]
    ds_write_b128 v203, v[172:175]
    ds_write_b128 v204, v[176:179]
    ds_write_b128 v205, v[180:183]
    ds_write_b128 v206, v[184:187]
    ds_write_b128 v207, v[188:191]
    s_mov_b64 exec, -1
    s_waitcnt lgkmcnt(0)
    v_or_b32 v25, 0, v18
    v_xor_b32 v25, v25, v19
    v_lshl_add_u32 v25, v25, 4, v24
    ds_read_b128 v[112:115], v25 offset:0
    v_or_b32 v25, 2, v18
    v_xor_b32 v25, v25, v19
    v_lshl_add_u32 v25, v25, 4, v24
    ds_read_b128 v[116:119], v25 offset:1024
    v_or_b32 v25, 4, v18
    v_xor_b32 v25, v25, v19
    v_lshl_add_u32 v25, v25, 4, v24
    ds_read_b128 v[120:123], v25 offset:2048
    v_or_b32 v25, 6, v18
    v_xor_b32 v25, v25, v19
    v_lshl_add_u32 v25, v25, 4, v24
    ds_read_b128 v[124:127], v25 offset:3072
    s_waitcnt lgkmcnt(0)
    v_add_f32_dpp v48, v48, v48 row_ror:8 row_mask:0xf bank_mask:0xf
    v_add_f32_dpp v49, v49, v49 row_ror:8 row_mask:0xf bank_mask:0xf
    v_add_f32_dpp v50, v50, v50 row_ror:8 row_mask:0xf bank_mask:0xf
    v_add_f32_dpp v51, v51, v51 row_ror:8 row_mask:0xf bank_mask:0xf
    v_add_f32_dpp v52, v52, v52 row_ror:8 row_mask:0xf bank_mask:0xf
    v_add_f32_dpp v53, v53, v53 row_ror:8 row_mask:0xf bank_mask:0xf
    v_add_f32_dpp v54, v54, v54 row_ror:8 row_mask:0xf bank_mask:0xf
    v_add_f32_dpp v55, v55, v55 row_ror:8 row_mask:0xf bank_mask:0xf
    v_add_f32_dpp v56, v56, v56 row_ror:8 row_mask:0xf bank_mask:0xf
    v_add_f32_dpp v57, v57, v57 row_ror:8 row_mask:0xf bank_mask:0xf
    v_add_f32_dpp v58, v58, v58 row_ror:8 row_mask:0xf bank_mask:0xf
    v_add_f32_dpp v59, v59, v59 row_ror:8 row_mask:0xf bank_mask:0xf
    v_add_f32_dpp v60, v60, v60 row_ror:8 row_mask:0xf bank_mask:0xf
    v_add_f32_dpp v61, v61, v61 row_ror:8 row_mask:0xf bank_mask:0xf
    v_add_f32_dpp v62, v62, v62 row_ror:8 row_mask:0xf bank_mask:0xf
    v_add_f32_dpp v63, v63, v63 row_ror:8 row_mask:0xf bank_mask:0xf
    v_mov_b32 v160, v48
    v_mov_b32 v161, v49
    v_mov_b32 v162, v50
    v_mov_b32 v163, v51
    v_mov_b32 v164, v52
    v_mov_b32 v165, v53
    v_mov_b32 v166, v54
    v_mov_b32 v167, v55
    v_mov_b32 v168, v56
    v_mov_b32 v169, v57
    v_mov_b32 v170, v58
    v_mov_b32 v171, v59
    v_mov_b32 v172, v60
    v_mov_b32 v173, v61
    v_mov_b32 v174, v62
    v_mov_b32 v175, v63
    v_permlane16_swap_b32 v48, v160
    v_permlane16_swap_b32 v49, v161
    v_permlane16_swap_b32 v50, v162
    v_permlane16_swap_b32 v51, v163
    v_permlane16_swap_b32 v52, v164
    v_permlane16_swap_b32 v53, v165
    v_permlane16_swap_b32 v54, v166
    v_permlane16_swap_b32 v55, v167
    v_permlane16_swap_b32 v56, v168
    v_permlane16_swap_b32 v57, v169
    v_permlane16_swap_b32 v58, v170
    v_permlane16_swap_b32 v59, v171
    v_permlane16_swap_b32 v60, v172
    v_permlane16_swap_b32 v61, v173
    v_permlane16_swap_b32 v62, v174
    v_permlane16_swap_b32 v63, v175
    v_add_f32 v48, v48, v160
    v_add_f32 v49, v49, v161
    v_add_f32 v50, v50, v162
    v_add_f32 v51, v51, v163
    v_add_f32 v52, v52, v164
    v_add_f32 v53, v53, v165
    v_add_f32 v54, v54, v166
    v_add_f32 v55, v55, v167
    v_add_f32 v56, v56, v168
    v_add_f32 v57, v57, v169
    v_add_f32 v58, v58, v170
    v_add_f32 v59, v59, v171
    v_add_f32 v60, v60, v172
    v_add_f32 v61, v61, v173
    v_add_f32 v62, v62, v174
    v_add_f32 v63, v63, v175
    v_mov_b32 v160, v48
    v_mov_b32 v161, v49
    v_mov_b32 v162, v50
    v_mov_b32 v163, v51
    v_mov_b32 v164, v52
    v_mov_b32 v165, v53
    v_mov_b32 v166, v54
    v_mov_b32 v167, v55
    v_mov_b32 v168, v56
    v_mov_b32 v169, v57
    v_mov_b32 v170, v58
    v_mov_b32 v171, v59
    v_mov_b32 v172, v60
    v_mov_b32 v173, v61
    v_mov_b32 v174, v62
    v_mov_b32 v175, v63
    v_permlane32_swap_b32 v48, v160
    v_permlane32_swap_b32 v49, v161
    v_permlane32_swap_b32 v50, v162
    v_permlane32_swap_b32 v51, v163
    v_permlane32_swap_b32 v52, v164
    v_permlane32_swap_b32 v53, v165
    v_permlane32_swap_b32 v54, v166
    v_permlane32_swap_b32 v55, v167
    v_permlane32_swap_b32 v56, v168
    v_permlane32_swap_b32 v57, v169
    v_permlane32_swap_b32 v58, v170
    v_permlane32_swap_b32 v59, v171
    v_permlane32_swap_b32 v60, v172
    v_permlane32_swap_b32 v61, v173
    v_permlane32_swap_b32 v62, v174
    v_permlane32_swap_b32 v63, v175
    v_add_f32 v48, v48, v160
    v_add_f32 v49, v49, v161
    v_add_f32 v50, v50, v162
    v_add_f32 v51, v51, v163
    v_add_f32 v52, v52, v164
    v_add_f32 v53, v53, v165
    v_add_f32 v54, v54, v166
    v_add_f32 v55, v55, v167
    v_add_f32 v56, v56, v168
    v_add_f32 v57, v57, v169
    v_add_f32 v58, v58, v170
    v_add_f32 v59, v59, v171
    v_add_f32 v60, v60, v172
    v_add_f32 v61, v61, v173
    v_add_f32 v62, v62, v174
    v_add_f32 v63, v63, v175
    v_lshlrev_b32 v26, 10, v18
    v_bfe_u32 v27, v2, 4, 1
    v_lshl_add_u32 v26, v27, 9, v26
    v_lshl_add_u32 v26, v19, 4, v26
    s_mul_i32 s46, s41, 135168
    s_lshl_b32 s47, s44, 12
    s_add_u32 s46, s46, s47
    s_lshl_b32 s47, s43, 8
    s_add_u32 s46, s46, s47
    s_waitcnt lgkmcnt(0)
    s_add_u32 s47, s46, 0
    buffer_store_dwordx4 v[96:99], v26, s[28:31], s47 offen offset:0 sc1
    s_add_u32 s47, s46, 0
    buffer_store_dwordx4 v[100:103], v26, s[28:31], s47 offen offset:2048 sc1
    s_add_u32 s47, s46, 33792
    buffer_store_dwordx4 v[104:107], v26, s[28:31], s47 offen offset:0 sc1
    s_add_u32 s47, s46, 33792
    buffer_store_dwordx4 v[108:111], v26, s[28:31], s47 offen offset:2048 sc1
    s_add_u32 s47, s46, 67584
    buffer_store_dwordx4 v[112:115], v26, s[28:31], s47 offen offset:0 sc1
    s_add_u32 s47, s46, 67584
    buffer_store_dwordx4 v[116:119], v26, s[28:31], s47 offen offset:2048 sc1
    s_add_u32 s47, s46, 101376
    buffer_store_dwordx4 v[120:123], v26, s[28:31], s47 offen offset:0 sc1
    s_add_u32 s47, s46, 101376
    buffer_store_dwordx4 v[124:127], v26, s[28:31], s47 offen offset:2048 sc1
    s_lshl_b32 s46, s89, 12
    s_add_u32 s46, s46, 32768
    v_lshlrev_b32 v18, 6, v224
    v_add_u32 v18, s46, v18
    ds_write_b128 v18, v[48:51] offset:0
    ds_write_b128 v18, v[52:55] offset:16
    ds_write_b128 v18, v[56:59] offset:32
    ds_write_b128 v18, v[60:63] offset:48
    v_lshrrev_b32 v19, 3, v2
    v_lshlrev_b32 v19, 6, v19
    v_and_b32 v24, 7, v2
    v_lshl_add_u32 v19, v24, 2, v19
    v_add_u32 v19, s46, v19
    s_waitcnt lgkmcnt(0)
    ds_read_b32 v24, v19
    ds_read_b32 v25, v19 offset:32
    s_add_u32 s8, s86, 0x80000
    s_addc_u32 s9, s87, 0
    s_mov_b32 s10, 0x2b000
    s_mov_b32 s11, 0x20000
    s_lshl_b32 s47, s41, 6
    v_add_u32 v19, s47, v2
    v_cmp_gt_u32 vcc, 1376, v19
    s_mul_i32 s47, s43, 1376
    v_add_u32 v19, s47, v19
    v_lshlrev_b32 v19, 2, v19
    v_mov_b32 v20, 0x40000000
    v_cndmask_b32 v19, v20, v19, vcc
    s_mul_i32 s47, s44, 22016
    s_waitcnt lgkmcnt(0)
    buffer_store_dword v25, v19, s[8:11], s47 offen sc1
    s_add_u32 s47, s47, 11008
    buffer_store_dword v24, v19, s[8:11], s47 offen sc1
    s_waitcnt vmcnt(0)
    s_add_u32 s40, s40, 1408
    s_lshl_b32 s40, s40, 7
    v_mov_b32 v20, s40
    v_mov_b32 v21, s88
    s_mov_b64 exec, 1
    buffer_store_dword v21, v20, s[92:95], 0 offen sc1
    s_mov_b64 exec, -1
UP_END:
P2_PUB:
    s_mov_b32 s60, s86
    s_mov_b32 s61, s87
    s_mov_b32 s62, 0x1c00000
    s_mov_b32 s63, 0x20000
    s_and_b32 s6, s90, 7
    s_lshr_b32 s7, s90, 3
    s_lshl_b32 s20, s6, 2
    s_lshr_b32 s21, s7, 3
    s_add_u32 s20, s20, s21
    s_and_b32 s36, s7, 7
    s_lshl_b32 s21, s36, 3
    s_lshr_b32 s19, s89, 2
    s_and_b32 s22, s89, 3
    s_lshl_b32 s22, s22, 1
    s_add_u32 s21, s21, s22
    s_add_u32 s28, s21, s19
    s_xor_b32 s29, s19, 1
    s_add_u32 s29, s21, s29
    s_lshl_b32 s22, s20, 16
    s_add_u32 s22, s22, 5242880
    s_lshl_b32 s16, s28, 10
    s_add_u32 s16, s16, s22
    s_lshl_b32 s17, s29, 10
    s_add_u32 s17, s17, s22
    s_lshl_b32 s24, s89, 10
    s_add_u32 s25, s22, s24
    s_add_u32 s25, s25, 2097152
    s_lshl_b32 s18, s28, 15
    s_lshl_b32 s23, s20, 10
    s_add_u32 s18, s18, s23
    s_add_u32 s18, s18, 11534336
    s_lshl_b32 s30, s36, 5
    s_add_u32 s30, s30, s20
    s_add_u32 s30, s30, 640
    v_lshrrev_b32 v152, 5, v2
    v_lshlrev_b32 v152, 8, v152
    v_and_b32 v153, 15, v2
    v_lshl_add_u32 v152, v153, 4, v152
    v_bfe_u32 v153, v2, 4, 1
    v_sub_u32 v154, 1, v153
    v_lshlrev_b32 v151, 12, v154
    s_mul_i32 s26, s19, 53248
    v_add_u32 v148, s26, v3
    s_add_u32 s26, s26, 0x10000
    v_mul_lo_u32 v154, v154, s26
    v_lshlrev_b32 v153, 17, v153
    v_add3_u32 v150, v152, v153, v154
    v_mov_b32 v149, v150
    v_mov_b32 v68, 0
    v_mov_b32 v69, 0
    v_mov_b32 v70, 0
    v_mov_b32 v71, 0
    v_mov_b32 v72, 0
    v_mov_b32 v73, 0
    v_mov_b32 v74, 0
    v_mov_b32 v75, 0
    v_mov_b32 v76, 0
    v_mov_b32 v77, 0
    v_mov_b32 v78, 0
    v_mov_b32 v79, 0
    v_mov_b32 v80, 0
    v_mov_b32 v81, 0
    v_mov_b32 v82, 0
    v_mov_b32 v83, 0
    v_mov_b32 v84, 0
    v_mov_b32 v85, 0
    v_mov_b32 v86, 0
    v_mov_b32 v87, 0
    v_mov_b32 v88, 0
    v_mov_b32 v89, 0
    v_mov_b32 v90, 0
    v_mov_b32 v91, 0
    v_mov_b32 v92, 0
    v_mov_b32 v93, 0
    v_mov_b32 v94, 0
    v_mov_b32 v95, 0
    v_mov_b32 v96, 0
    v_mov_b32 v97, 0
    v_mov_b32 v98, 0
    v_mov_b32 v99, 0
    v_mov_b32 v144, 0
    v_mov_b32 v145, 0
    v_mov_b32 v146, 0
    v_mov_b32 v147, 0
    v_mov_b32 v32, 0
    v_mov_b32 v33, 0
    v_mov_b32 v34, 0
    v_mov_b32 v35, 0
    v_and_b32 v36, 31, v0
    v_cmp_gt_u32 vcc, 2, v36
    v_mov_b32 v37, 0x3f803f80
    v_lshlrev_b32 v38, 3, v0
    v_cndmask_b32 v36, 0, v37, vcc
    v_add_u32 v38, 0x20000, v38
    v_mov_b32 v37, v36
    s_cmp_eq_u32 s89, 0
    s_cbranch_scc0 WAIT_14_B
    s_cmp_lg_u32 s88, 0
    s_cbranch_scc1 NONCE_15_OK
    s_waitcnt vmcnt(0)
    v_readfirstlane_b32 s88, v249
    s_nop 1
    s_cmp_lg_u32 s88, 0
    s_cbranch_scc1 NONCE_15_OK
    s_mov_b32 s98, 0
NONCE_15_L:
    v_mov_b32 v250, 0
    global_load_dword v251, v250, s[84:85] sc1
    s_waitcnt vmcnt(0)
    v_readfirstlane_b32 s88, v251
    s_add_u32 s98, s98, 1
    s_cmp_gt_u32 s98, 0x4000
    s_cbranch_scc1 NONCE_15_OK
    s_cmp_eq_u32 s88, 0
    s_cbranch_scc1 NONCE_15_L
NONCE_15_OK:
    v_and_b32 v250, 15, v2
    v_mul_u32_u24 v250, 12, v250
    v_lshrrev_b32 v252, 4, v2
    v_lshl_add_u32 v250, v252, 2, v250
    s_lshr_b32 s98, s20, 3
    s_add_u32 s98, s98, 384
    v_add_u32 v250, s98, v250
    v_mov_b32 v252, 363
    v_cmp_le_u32 vcc, 48, v2
    s_nop 1
    v_cndmask_b32 v250, v250, v252, vcc
    v_lshlrev_b32 v250, 7, v250
    s_mov_b32 s98, 0
    buffer_load_dword v251, v250, s[92:95], 0 offen sc1
WAIT_14_L:
    buffer_load_dword v254, v250, s[92:95], 0 offen sc1
    s_waitcnt vmcnt(1)
    v_cmp_ne_u32 vcc, s88, v251
    s_nop 1
    s_cmp_eq_u64 vcc, 0
    s_cbranch_scc1 WAIT_14_E
    buffer_load_dword v251, v250, s[92:95], 0 offen sc1
    s_add_u32 s98, s98, 1
    s_waitcnt vmcnt(1)
    v_cmp_ne_u32 vcc, s88, v254
    s_nop 1
    s_cmp_eq_u64 vcc, 0
    s_cbranch_scc1 WAIT_14_E
    s_cmp_gt_u32 s98, 0x2000
    s_cbranch_scc0 WAIT_14_L
WAIT_14_E:
WAIT_14_B:
    s_barrier
    buffer_load_dwordx4 v[4:7], v3, s[60:63], s16 offen sc1
    buffer_load_dwordx4 v[8:11], v3, s[60:63], s17 offen sc1
    s_add_u32 m0, s24, 0
    s_add_u32 s26, s25, 0
    buffer_load_dwordx4 v3, s[60:63], s26 offen sc1 lds
    s_add_u32 m0, s24, 65536
    s_add_u32 s26, s25, 2097152
    buffer_load_dwordx4 v3, s[60:63], s26 offen sc1 lds
    s_add_u32 m0, s24, 49152
    s_add_u32 s26, s25, 49152
    buffer_load_dwordx4 v3, s[60:63], s26 offen sc1 lds
    s_add_u32 m0, s24, 114688
    s_add_u32 s26, s25, 2146304
    buffer_load_dwordx4 v3, s[60:63], s26 offen sc1 lds
    s_add_u32 m0, s24, 57344
    s_add_u32 s26, s25, 57344
    buffer_load_dwordx4 v3, s[60:63], s26 offen sc1 lds
    s_add_u32 m0, s24, 122880
    s_add_u32 s26, s25, 2154496
    buffer_load_dwordx4 v3, s[60:63], s26 offen sc1 lds
    ds_write_b64 v38, v[36:37]
    ds_write_b64 v38, v[36:37] offset:1024
    s_lshl_b32 s44, s6, 3
    s_lshr_b32 s45, s7, 2
    s_add_u32 s44, s44, s45
    s_and_b32 s45, s7, 3
    s_lshl_b32 s46, s45, 2
    s_and_b32 s47, s89, 3
    s_add_u32 s46, s46, s47
    s_lshl_b32 s37, s46, 15
    s_lshl_b32 s38, s19, 14
    s_add_u32 s37, s37, s38
    s_add_u32 s37, s37, 13631488
    s_lshl_b32 s38, s19, 4
    v_xor_b32 v156, s38, v2
    v_lshlrev_b32 v156, 4, v156
    s_waitcnt vmcnt(0) lgkmcnt(0)
    s_barrier
    ds_read_b128 v[20:23], v3
    ds_read_b128 v[12:15], v148
    ds_read_b128 v[16:19], v148 offset:1024
    s_waitcnt lgkmcnt(2)
    v_mfma_f32_32x32x16_bf16 v[36:51], v[20:23], v[4:7], 0
    v_mfma_f32_32x32x16_bf16 v[52:67], v[20:23], v[8:11], 0
    ds_read_b128 v[20:23], v149
    ds_read_b128 v[24:27], v149 offset:512
    s_nop 8
    v_max3_f32 v152, v36, v37, v38
    v_max3_f32 v154, v44, v45, v46
    v_max3_f32 v153, v52, v53, v54
    v_max3_f32 v155, v60, v61, v62
    v_max3_f32 v152, v152, v39, v40
    v_max3_f32 v154, v154, v47, v48
    v_max3_f32 v153, v153, v55, v56
    v_max3_f32 v155, v155, v63, v64
    v_max3_f32 v152, v152, v41, v42
    v_max3_f32 v154, v154, v49, v50
    v_max3_f32 v153, v153, v57, v58
    v_max3_f32 v155, v155, v65, v66
    v_max3_f32 v154, v154, v43, v51
    v_max3_f32 v155, v155, v59, v67
    v_max_f32 v152, v152, v154
    v_max_f32 v153, v153, v155
    v_mov_b32 v154, v152
    v_mov_b32 v155, v153
    s_nop 0
    v_permlane32_swap_b32 v152, v154
    v_permlane32_swap_b32 v153, v155
    v_max_f32 v152, v152, v154
    v_max_f32 v153, v153, v155
    v_sub_f32 v152, 0xc2200000, v152
    v_sub_f32 v153, 0xc2200000, v153
    v_mov_b32 v101, v152
    v_mov_b32 v100, v152
    v_mov_b32 v117, v153
    v_mov_b32 v116, v153
    v_pk_mov_b32 v[102:103], v[100:101], v[100:101]
    v_pk_mov_b32 v[104:105], v[100:101], v[100:101]
    v_pk_mov_b32 v[106:107], v[100:101], v[100:101]
    v_pk_mov_b32 v[108:109], v[100:101], v[100:101]
    v_pk_mov_b32 v[110:111], v[100:101], v[100:101]
    v_pk_mov_b32 v[112:113], v[100:101], v[100:101]
    v_pk_mov_b32 v[114:115], v[100:101], v[100:101]
    s_waitcnt lgkmcnt(2)
    s_nop 0
    v_mfma_f32_32x32x16_bf16 v[36:51], v[12:15], v[4:7], v[100:115]
    v_pk_mov_b32 v[118:119], v[116:117], v[116:117]
    v_pk_mov_b32 v[120:121], v[116:117], v[116:117]
    v_pk_mov_b32 v[122:123], v[116:117], v[116:117]
    v_pk_mov_b32 v[124:125], v[116:117], v[116:117]
    v_pk_mov_b32 v[126:127], v[116:117], v[116:117]
    v_pk_mov_b32 v[128:129], v[116:117], v[116:117]
    v_pk_mov_b32 v[130:131], v[116:117], v[116:117]
    s_nop 1
    v_mfma_f32_32x32x16_bf16 v[52:67], v[12:15], v[8:11], v[116:131]
    s_cmp_eq_u32 s19, 0
    s_cbranch_scc0 P3_LOWP0
    s_setprio 1
P3_LOWP0:
    v_min_u32 v158, 58, v2
    v_add_u32 v158, 304, v158
    v_lshlrev_b32 v158, 7, v158
    buffer_load_dword v157, v158, s[92:95], 0 offen sc1
    s_mov_b32 s31, 0
    s_nop 3
    s_waitcnt lgkmcnt(0)
    v_exp_f32 v36, v36
    ds_read_b128 v[12:15], v148 offset:2048
    v_exp_f32 v37, v37
    ds_read_b128 v[28:31], v149 offset:1024
    v_exp_f32 v38, v38
    s_add_u32 m0, s24, 8192
    s_add_u32 s26, s25, 8192
    buffer_load_dwordx4 v3, s[60:63], s26 offen sc1 lds
    v_exp_f32 v39, v39
    v_mfma_f32_32x32x16_bf16 v[84:99], v[32:35], v[144:147], v[84:99]
    v_exp_f32 v40, v40
    ds_read_b128 v[32:35], v149 offset:1536
    v_exp_f32 v41, v41
    s_add_u32 m0, s24, 73728
    s_add_u32 s26, s25, 2105344
    buffer_load_dwordx4 v3, s[60:63], s26 offen sc1 lds
    v_exp_f32 v42, v42
    v_exp_f32 v43, v43
    v_cvt_pk_bf16_f32 v132, v36, v37
    v_cvt_pk_bf16_f32 v133, v38, v39
    v_cvt_pk_bf16_f32 v134, v40, v41
    v_cvt_pk_bf16_f32 v135, v42, v43
    v_exp_f32 v44, v44
    s_add_u32 m0, s24, 16384
    s_add_u32 s26, s25, 16384
    buffer_load_dwordx4 v3, s[60:63], s26 offen sc1 lds
    v_exp_f32 v45, v45
    v_mfma_f32_32x32x16_bf16 v[68:83], v[20:23], v[132:135], v[68:83]
    v_exp_f32 v46, v46
    v_exp_f32 v47, v47
    v_exp_f32 v48, v48
    v_exp_f32 v49, v49
    v_exp_f32 v50, v50
    v_exp_f32 v51, v51
    v_cvt_pk_bf16_f32 v136, v44, v45
    v_cvt_pk_bf16_f32 v137, v46, v47
    v_cvt_pk_bf16_f32 v138, v48, v49
    v_cvt_pk_bf16_f32 v139, v50, v51
    v_mfma_f32_32x32x16_bf16 v[36:51], v[16:19], v[4:7], v[100:115]
    v_exp_f32 v52, v52
    v_exp_f32 v53, v53
    v_exp_f32 v54, v54
    v_exp_f32 v55, v55
    v_mfma_f32_32x32x16_bf16 v[68:83], v[24:27], v[136:139], v[68:83]
    v_exp_f32 v56, v56
    v_exp_f32 v57, v57
    v_exp_f32 v58, v58
    v_exp_f32 v59, v59
    v_cvt_pk_bf16_f32 v140, v52, v53
    v_cvt_pk_bf16_f32 v141, v54, v55
    v_cvt_pk_bf16_f32 v142, v56, v57
    v_cvt_pk_bf16_f32 v143, v58, v59
    v_exp_f32 v60, v60
    v_exp_f32 v61, v61
    v_mfma_f32_32x32x16_bf16 v[84:99], v[20:23], v[140:143], v[84:99]
    v_exp_f32 v62, v62
    v_exp_f32 v63, v63
    v_exp_f32 v64, v64
    v_exp_f32 v65, v65
    v_exp_f32 v66, v66
    v_exp_f32 v67, v67
    v_cvt_pk_bf16_f32 v144, v60, v61
    v_cvt_pk_bf16_f32 v145, v62, v63
    v_cvt_pk_bf16_f32 v146, v64, v65
    v_cvt_pk_bf16_f32 v147, v66, v67
    v_mfma_f32_32x32x16_bf16 v[52:67], v[16:19], v[8:11], v[116:131]
    s_waitcnt lgkmcnt(0)
    v_exp_f32 v36, v36
    ds_read_b128 v[16:19], v148 offset:3072
    v_exp_f32 v37, v37
    ds_read_b128 v[20:23], v149 offset:2048
    v_exp_f32 v38, v38
    s_add_u32 m0, s24, 81920
    s_add_u32 s26, s25, 2113536
    buffer_load_dwordx4 v3, s[60:63], s26 offen sc1 lds
    v_exp_f32 v39, v39
    v_mfma_f32_32x32x16_bf16 v[84:99], v[24:27], v[144:147], v[84:99]
    v_exp_f32 v40, v40
    ds_read_b128 v[24:27], v149 offset:2560
    v_exp_f32 v41, v41
    s_add_u32 m0, s24, 24576
    s_add_u32 s26, s25, 24576
    buffer_load_dwordx4 v3, s[60:63], s26 offen sc1 lds
    v_exp_f32 v42, v42
    v_exp_f32 v43, v43
    v_cvt_pk_bf16_f32 v132, v36, v37
    v_cvt_pk_bf16_f32 v133, v38, v39
    v_cvt_pk_bf16_f32 v134, v40, v41
    v_cvt_pk_bf16_f32 v135, v42, v43
    v_exp_f32 v44, v44
    s_add_u32 m0, s24, 90112
    s_add_u32 s26, s25, 2121728
    buffer_load_dwordx4 v3, s[60:63], s26 offen sc1 lds
    v_exp_f32 v45, v45
    v_mfma_f32_32x32x16_bf16 v[68:83], v[28:31], v[132:135], v[68:83]
    v_exp_f32 v46, v46
    v_exp_f32 v47, v47
    v_exp_f32 v48, v48
    v_exp_f32 v49, v49
    v_exp_f32 v50, v50
    v_exp_f32 v51, v51
    v_cvt_pk_bf16_f32 v136, v44, v45
    v_cvt_pk_bf16_f32 v137, v46, v47
    v_cvt_pk_bf16_f32 v138, v48, v49
    v_cvt_pk_bf16_f32 v139, v50, v51
    v_mfma_f32_32x32x16_bf16 v[36:51], v[12:15], v[4:7], v[100:115]
    v_exp_f32 v52, v52
    v_exp_f32 v53, v53
    v_exp_f32 v54, v54
    v_exp_f32 v55, v55
    v_mfma_f32_32x32x16_bf16 v[68:83], v[32:35], v[136:139], v[68:83]
    v_exp_f32 v56, v56
    v_exp_f32 v57, v57
    v_exp_f32 v58, v58
    v_exp_f32 v59, v59
    v_cvt_pk_bf16_f32 v140, v52, v53
    v_cvt_pk_bf16_f32 v141, v54, v55
    v_cvt_pk_bf16_f32 v142, v56, v57
    v_cvt_pk_bf16_f32 v143, v58, v59
    v_exp_f32 v60, v60
    v_exp_f32 v61, v61
    v_mfma_f32_32x32x16_bf16 v[84:99], v[28:31], v[140:143], v[84:99]
    v_exp_f32 v62, v62
    v_exp_f32 v63, v63
    v_exp_f32 v64, v64
    v_exp_f32 v65, v65
    v_exp_f32 v66, v66
    v_exp_f32 v67, v67
    v_cvt_pk_bf16_f32 v144, v60, v61
    v_cvt_pk_bf16_f32 v145, v62, v63
    v_cvt_pk_bf16_f32 v146, v64, v65
    v_cvt_pk_bf16_f32 v147, v66, v67
    v_mfma_f32_32x32x16_bf16 v[52:67], v[12:15], v[8:11], v[116:131]
    s_waitcnt lgkmcnt(0)
    v_exp_f32 v36, v36
    ds_read_b128 v[12:15], v148 offset:4096
    v_exp_f32 v37, v37
    ds_read_b128 v[28:31], v149 offset:3072
    v_exp_f32 v38, v38
    s_add_u32 m0, s24, 32768
    s_add_u32 s26, s25, 32768
    buffer_load_dwordx4 v3, s[60:63], s26 offen sc1 lds
    v_exp_f32 v39, v39
    v_mfma_f32_32x32x16_bf16 v[84:99], v[32:35], v[144:147], v[84:99]
    v_exp_f32 v40, v40
    ds_read_b128 v[32:35], v149 offset:3584
    v_exp_f32 v41, v41
    s_add_u32 m0, s24, 98304
    s_add_u32 s26, s25, 2129920
    buffer_load_dwordx4 v3, s[60:63], s26 offen sc1 lds
    v_exp_f32 v42, v42
    v_exp_f32 v43, v43
    v_cvt_pk_bf16_f32 v132, v36, v37
    v_cvt_pk_bf16_f32 v133, v38, v39
    v_cvt_pk_bf16_f32 v134, v40, v41
    v_cvt_pk_bf16_f32 v135, v42, v43
    v_exp_f32 v44, v44
    s_add_u32 m0, s24, 40960
    s_add_u32 s26, s25, 40960
    buffer_load_dwordx4 v3, s[60:63], s26 offen sc1 lds
    v_exp_f32 v45, v45
    v_mfma_f32_32x32x16_bf16 v[68:83], v[20:23], v[132:135], v[68:83]
    v_exp_f32 v46, v46
    v_exp_f32 v47, v47
    v_exp_f32 v48, v48
    v_exp_f32 v49, v49
    v_exp_f32 v50, v50
    v_exp_f32 v51, v51
    v_cvt_pk_bf16_f32 v136, v44, v45
    v_cvt_pk_bf16_f32 v137, v46, v47
    v_cvt_pk_bf16_f32 v138, v48, v49
    v_cvt_pk_bf16_f32 v139, v50, v51
    v_mfma_f32_32x32x16_bf16 v[36:51], v[16:19], v[4:7], v[100:115]
    v_exp_f32 v52, v52
    v_exp_f32 v53, v53
    v_exp_f32 v54, v54
    v_exp_f32 v55, v55
    v_mfma_f32_32x32x16_bf16 v[68:83], v[24:27], v[136:139], v[68:83]
    v_exp_f32 v56, v56
    v_exp_f32 v57, v57
    v_exp_f32 v58, v58
    v_exp_f32 v59, v59
    v_cvt_pk_bf16_f32 v140, v52, v53
    v_cvt_pk_bf16_f32 v141, v54, v55
    v_cvt_pk_bf16_f32 v142, v56, v57
    v_cvt_pk_bf16_f32 v143, v58, v59
    v_exp_f32 v60, v60
    v_exp_f32 v61, v61
    v_mfma_f32_32x32x16_bf16 v[84:99], v[20:23], v[140:143], v[84:99]
    v_exp_f32 v62, v62
    v_exp_f32 v63, v63
    v_exp_f32 v64, v64
    v_exp_f32 v65, v65
    v_exp_f32 v66, v66
    v_exp_f32 v67, v67
    v_cvt_pk_bf16_f32 v144, v60, v61
    v_cvt_pk_bf16_f32 v145, v62, v63
    v_cvt_pk_bf16_f32 v146, v64, v65
    v_cvt_pk_bf16_f32 v147, v66, v67
    v_mfma_f32_32x32x16_bf16 v[52:67], v[16:19], v[8:11], v[116:131]
    s_waitcnt lgkmcnt(0)
    v_exp_f32 v36, v36
    ds_read_b128 v[16:19], v148 offset:5120
    v_exp_f32 v37, v37
    ds_read_b128 v[20:23], v149 offset:4096
    v_exp_f32 v38, v38
    s_add_u32 m0, s24, 106496
    s_add_u32 s26, s25, 2138112
    buffer_load_dwordx4 v3, s[60:63], s26 offen sc1 lds
    v_exp_f32 v39, v39
    v_mfma_f32_32x32x16_bf16 v[84:99], v[24:27], v[144:147], v[84:99]
    v_exp_f32 v40, v40
    ds_read_b128 v[24:27], v149 offset:4608
    v_exp_f32 v41, v41
    v_exp_f32 v42, v42
    v_exp_f32 v43, v43
    v_cvt_pk_bf16_f32 v132, v36, v37
    v_cvt_pk_bf16_f32 v133, v38, v39
    v_cvt_pk_bf16_f32 v134, v40, v41
    v_cvt_pk_bf16_f32 v135, v42, v43
    v_exp_f32 v44, v44
    v_exp_f32 v45, v45
    v_mfma_f32_32x32x16_bf16 v[68:83], v[28:31], v[132:135], v[68:83]
    v_exp_f32 v46, v46
    v_exp_f32 v47, v47
    v_exp_f32 v48, v48
    v_exp_f32 v49, v49
    v_exp_f32 v50, v50
    v_exp_f32 v51, v51
    v_cvt_pk_bf16_f32 v136, v44, v45
    v_cvt_pk_bf16_f32 v137, v46, v47
    v_cvt_pk_bf16_f32 v138, v48, v49
    v_cvt_pk_bf16_f32 v139, v50, v51
    v_mfma_f32_32x32x16_bf16 v[36:51], v[12:15], v[4:7], v[100:115]
    v_exp_f32 v52, v52
    v_exp_f32 v53, v53
    v_exp_f32 v54, v54
    v_exp_f32 v55, v55
    v_mfma_f32_32x32x16_bf16 v[68:83], v[32:35], v[136:139], v[68:83]
    v_exp_f32 v56, v56
    v_exp_f32 v57, v57
    v_exp_f32 v58, v58
    v_exp_f32 v59, v59
    v_cvt_pk_bf16_f32 v140, v52, v53
    v_cvt_pk_bf16_f32 v141, v54, v55
    v_cvt_pk_bf16_f32 v142, v56, v57
    v_cvt_pk_bf16_f32 v143, v58, v59
    v_exp_f32 v60, v60
    v_exp_f32 v61, v61
    v_mfma_f32_32x32x16_bf16 v[84:99], v[28:31], v[140:143], v[84:99]
    v_exp_f32 v62, v62
    v_exp_f32 v63, v63
    v_exp_f32 v64, v64
    v_exp_f32 v65, v65
    v_exp_f32 v66, v66
    v_exp_f32 v67, v67
    v_cvt_pk_bf16_f32 v144, v60, v61
    v_cvt_pk_bf16_f32 v145, v62, v63
    v_cvt_pk_bf16_f32 v146, v64, v65
    v_cvt_pk_bf16_f32 v147, v66, v67
    v_mfma_f32_32x32x16_bf16 v[52:67], v[12:15], v[8:11], v[116:131]
    v_add_u32 v148, 0x1000, v148
    v_add_u32 v149, v149, v151
    s_waitcnt vmcnt(0)
    v_cmp_ne_u32 vcc, s88, v157
    s_nop 1
    s_cmp_eq_u64 vcc, 0
    s_cbranch_scc1 P3_WOOK
    s_mov_b32 s98, 0
P3_WOL:
    buffer_load_dword v157, v158, s[92:95], 0 offen sc1
    s_add_u32 s98, s98, 1
    s_cmp_gt_u32 s98, 0x4000
    s_cbranch_scc1 P3_WOOK
    s_waitcnt vmcnt(0)
    v_cmp_ne_u32 vcc, s88, v157
    s_nop 1
    s_cmp_lg_u64 vcc, 0
    s_cbranch_scc1 P3_WOL
P3_WOOK:
    s_barrier
    s_waitcnt lgkmcnt(0)
    v_exp_f32 v36, v36
    ds_read_b128 v[12:15], v148 offset:2048
    v_exp_f32 v37, v37
    ds_read_b128 v[28:31], v149 offset:1024
    v_exp_f32 v38, v38
    buffer_load_dwordx4 v[160:163], v156, s[60:63], s37 offen offset:0 sc1
    v_exp_f32 v39, v39
    v_mfma_f32_32x32x16_bf16 v[84:99], v[32:35], v[144:147], v[84:99]
    v_exp_f32 v40, v40
    ds_read_b128 v[32:35], v149 offset:1536
    v_exp_f32 v41, v41
    s_mov_b32 s8, s64
    s_mov_b32 s9, s65
    s_mov_b32 s10, 2097152
    s_mov_b32 s11, 0x20000
    v_exp_f32 v42, v42
    v_exp_f32 v43, v43
    v_cvt_pk_bf16_f32 v132, v36, v37
    v_cvt_pk_bf16_f32 v133, v38, v39
    v_cvt_pk_bf16_f32 v134, v40, v41
    v_cvt_pk_bf16_f32 v135, v42, v43
    v_exp_f32 v44, v44
    buffer_load_dwordx4 v[164:167], v156, s[60:63], s37 offen offset:1024 sc1
    v_exp_f32 v45, v45
    v_mfma_f32_32x32x16_bf16 v[68:83], v[20:23], v[132:135], v[68:83]
    v_exp_f32 v46, v46
    v_exp_f32 v47, v47
    s_lshl_b32 s49, s44, 15
    s_lshl_b32 s48, s46, 6
    s_add_u32 s49, s49, s48
    s_lshl_b32 s48, s19, 5
    s_add_u32 s49, s49, s48
    v_and_b32 v240, 31, v2
    v_lshrrev_b32 v241, 5, v2
    v_exp_f32 v48, v48
    v_exp_f32 v49, v49
    v_exp_f32 v50, v50
    v_exp_f32 v51, v51
    v_cvt_pk_bf16_f32 v136, v44, v45
    v_cvt_pk_bf16_f32 v137, v46, v47
    v_cvt_pk_bf16_f32 v138, v48, v49
    v_cvt_pk_bf16_f32 v139, v50, v51
    v_mfma_f32_32x32x16_bf16 v[36:51], v[16:19], v[4:7], v[100:115]
    v_exp_f32 v52, v52
    v_exp_f32 v53, v53
    v_exp_f32 v54, v54
    buffer_load_dwordx4 v[168:171], v156, s[60:63], s37 offen offset:2048 sc1
    v_exp_f32 v55, v55
    v_mfma_f32_32x32x16_bf16 v[68:83], v[24:27], v[136:139], v[68:83]
    v_exp_f32 v56, v56
    v_exp_f32 v57, v57
    v_lshlrev_b32 v159, 10, v240
    v_lshl_add_u32 v159, v241, 3, v159
    buffer_load_dwordx2 v[224:225], v159, s[8:11], s49 offen
    buffer_load_dwordx2 v[226:227], v159, s[8:11], s49 offen offset:16
    v_exp_f32 v58, v58
    v_exp_f32 v59, v59
    v_cvt_pk_bf16_f32 v140, v52, v53
    v_cvt_pk_bf16_f32 v141, v54, v55
    v_cvt_pk_bf16_f32 v142, v56, v57
    v_cvt_pk_bf16_f32 v143, v58, v59
    v_exp_f32 v60, v60
    buffer_load_dwordx4 v[172:175], v156, s[60:63], s37 offen offset:3072 sc1
    s_add_u32 s37, s37, 4096
    v_exp_f32 v61, v61
    v_mfma_f32_32x32x16_bf16 v[84:99], v[20:23], v[140:143], v[84:99]
    v_exp_f32 v62, v62
    v_exp_f32 v63, v63
    s_lshl_b32 s57, s46, 7
    s_lshl_b32 s48, s19, 6
    s_add_u32 s57, s57, s48
    s_add_u32 s57, s57, 49152
    v_lshlrev_b32 v159, 4, v241
    buffer_load_dwordx4 v[228:231], v159, s[60:63], s57 offen sc1
    buffer_load_dwordx4 v[232:235], v159, s[60:63], s57 offen offset:32 sc1
    v_exp_f32 v64, v64
    v_exp_f32 v65, v65
    v_exp_f32 v66, v66
    v_exp_f32 v67, v67
    v_cvt_pk_bf16_f32 v144, v60, v61
    v_cvt_pk_bf16_f32 v145, v62, v63
    v_cvt_pk_bf16_f32 v146, v64, v65
    v_cvt_pk_bf16_f32 v147, v66, v67
    v_mfma_f32_32x32x16_bf16 v[52:67], v[16:19], v[8:11], v[116:131]
    s_waitcnt lgkmcnt(0)
    v_exp_f32 v36, v36
    ds_read_b128 v[16:19], v148 offset:3072
    v_exp_f32 v37, v37
    ds_read_b128 v[20:23], v149 offset:2048
    v_exp_f32 v38, v38
    buffer_load_dwordx4 v[176:179], v156, s[60:63], s37 offen offset:0 sc1
    v_exp_f32 v39, v39
    v_mfma_f32_32x32x16_bf16 v[84:99], v[24:27], v[144:147], v[84:99]
    v_exp_f32 v40, v40
    ds_read_b128 v[24:27], v149 offset:2560
    v_exp_f32 v41, v41
    s_lshl_b32 s48, s44, 15
    s_lshl_b32 s54, s89, 12
    s_add_u32 s48, s48, s54
    s_add_u32 s48, s48, 11534336
    s_lshl_b32 s54, s44, 15
    s_lshl_b32 s55, s46, 11
    v_exp_f32 v42, v42
    v_exp_f32 v43, v43
    v_cvt_pk_bf16_f32 v132, v36, v37
    v_cvt_pk_bf16_f32 v133, v38, v39
    v_cvt_pk_bf16_f32 v134, v40, v41
    v_cvt_pk_bf16_f32 v135, v42, v43
    v_exp_f32 v44, v44
    buffer_load_dwordx4 v[180:183], v156, s[60:63], s37 offen offset:1024 sc1
    v_exp_f32 v45, v45
    v_mfma_f32_32x32x16_bf16 v[68:83], v[28:31], v[132:135], v[68:83]
    v_exp_f32 v46, v46
    v_exp_f32 v47, v47
    s_add_u32 s54, s54, s55
    s_lshl_b32 s55, s19, 10
    s_add_u32 s54, s54, s55
    s_add_u32 s54, s54, 14680064
    s_lshl_b32 s55, s45, 14
    s_lshl_b32 s56, s44, 8
    v_exp_f32 v48, v48
    v_exp_f32 v49, v49
    v_exp_f32 v50, v50
    v_exp_f32 v51, v51
    v_cvt_pk_bf16_f32 v136, v44, v45
    v_cvt_pk_bf16_f32 v137, v46, v47
    v_cvt_pk_bf16_f32 v138, v48, v49
    v_cvt_pk_bf16_f32 v139, v50, v51
    v_mfma_f32_32x32x16_bf16 v[36:51], v[12:15], v[4:7], v[100:115]
    v_exp_f32 v52, v52
    v_exp_f32 v53, v53
    v_exp_f32 v54, v54
    buffer_load_dwordx4 v[184:187], v156, s[60:63], s37 offen offset:2048 sc1
    v_exp_f32 v55, v55
    v_mfma_f32_32x32x16_bf16 v[68:83], v[32:35], v[136:139], v[68:83]
    v_exp_f32 v56, v56
    v_exp_f32 v57, v57
    s_add_u32 s55, s55, s56
    s_add_u32 s55, s55, 16777216
    s_lshl_b32 s56, s44, 2
    s_add_u32 s56, s56, s45
    s_add_u32 s56, s56, 896
    s_lshr_b32 s47, s44, 3
    v_exp_f32 v58, v58
    v_exp_f32 v59, v59
    v_cvt_pk_bf16_f32 v140, v52, v53
    v_cvt_pk_bf16_f32 v141, v54, v55
    v_cvt_pk_bf16_f32 v142, v56, v57
    v_cvt_pk_bf16_f32 v143, v58, v59
    v_exp_f32 v60, v60
    buffer_load_dwordx4 v[188:191], v156, s[60:63], s37 offen offset:3072 sc1
    s_add_u32 s37, s37, 4096
    v_exp_f32 v61, v61
    v_mfma_f32_32x32x16_bf16 v[84:99], v[28:31], v[140:143], v[84:99]
    v_exp_f32 v62, v62
    v_exp_f32 v63, v63
    s_lshl_b32 s47, s47, 5
    s_add_u32 s47, s47, 640
    s_cmp_lt_u32 s7, 29
    s_cselect_b32 s52, 1, 0
    s_min_u32 s53, s7, 28
    s_mul_i32 s50, s6, 29
    v_exp_f32 v64, v64
    v_exp_f32 v65, v65
    v_exp_f32 v66, v66
    v_exp_f32 v67, v67
    v_cvt_pk_bf16_f32 v144, v60, v61
    v_cvt_pk_bf16_f32 v145, v62, v63
    v_cvt_pk_bf16_f32 v146, v64, v65
    v_cvt_pk_bf16_f32 v147, v66, v67
    v_mfma_f32_32x32x16_bf16 v[52:67], v[12:15], v[8:11], v[116:131]
    s_waitcnt lgkmcnt(0)
    v_exp_f32 v36, v36
    ds_read_b128 v[12:15], v148 offset:4096
    v_exp_f32 v37, v37
    ds_read_b128 v[28:31], v149 offset:3072
    v_exp_f32 v38, v38
    buffer_load_dwordx4 v[192:195], v156, s[60:63], s37 offen offset:0 sc1
    v_exp_f32 v39, v39
    v_mfma_f32_32x32x16_bf16 v[84:99], v[32:35], v[144:147], v[84:99]
    v_exp_f32 v40, v40
    ds_read_b128 v[32:35], v149 offset:3584
    v_exp_f32 v41, v41
    s_add_u32 s50, s50, s53
    s_cmp_ge_u32 s50, 116
    s_cselect_b32 s51, 116, 0
    s_cselect_b32 s53, 4, 0
    s_sub_u32 s51, s50, s51
    s_and_b32 s50, s51, 3
    v_exp_f32 v42, v42
    v_exp_f32 v43, v43
    v_cvt_pk_bf16_f32 v132, v36, v37
    v_cvt_pk_bf16_f32 v133, v38, v39
    v_cvt_pk_bf16_f32 v134, v40, v41
    v_cvt_pk_bf16_f32 v135, v42, v43
    v_exp_f32 v44, v44
    buffer_load_dwordx4 v[196:199], v156, s[60:63], s37 offen offset:1024 sc1
    v_exp_f32 v45, v45
    v_mfma_f32_32x32x16_bf16 v[68:83], v[20:23], v[132:135], v[68:83]
    v_exp_f32 v46, v46
    v_exp_f32 v47, v47
    s_add_u32 s50, s50, s53
    s_lshr_b32 s53, s51, 2
    s_mul_i32 s51, s53, 3
    s_min_u32 s51, s51, 83
    s_mul_i32 s58, s51, 33792
    s_lshl_b32 s59, s89, 10
    v_exp_f32 v48, v48
    v_exp_f32 v49, v49
    v_exp_f32 v50, v50
    v_exp_f32 v51, v51
    v_cvt_pk_bf16_f32 v136, v44, v45
    v_cvt_pk_bf16_f32 v137, v46, v47
    v_cvt_pk_bf16_f32 v138, v48, v49
    v_cvt_pk_bf16_f32 v139, v50, v51
    v_mfma_f32_32x32x16_bf16 v[36:51], v[16:19], v[4:7], v[100:115]
    v_exp_f32 v52, v52
    v_exp_f32 v53, v53
    v_exp_f32 v54, v54
    buffer_load_dwordx4 v[200:203], v156, s[60:63], s37 offen offset:2048 sc1
    v_exp_f32 v55, v55
    v_mfma_f32_32x32x16_bf16 v[68:83], v[24:27], v[136:139], v[68:83]
    v_exp_f32 v56, v56
    v_exp_f32 v57, v57
    s_add_u32 s58, s58, s59
    s_add_u32 s58, s58, 17825792
    s_mul_i32 s59, s89, 3072
    s_add_u32 s59, s59, 49152
    v_exp_f32 v58, v58
    v_exp_f32 v59, v59
    v_cvt_pk_bf16_f32 v140, v52, v53
    v_cvt_pk_bf16_f32 v141, v54, v55
    v_cvt_pk_bf16_f32 v142, v56, v57
    v_cvt_pk_bf16_f32 v143, v58, v59
    v_exp_f32 v60, v60
    buffer_load_dwordx4 v[204:207], v156, s[60:63], s37 offen offset:3072 sc1
    s_add_u32 s37, s37, 4096
    v_exp_f32 v61, v61
    v_mfma_f32_32x32x16_bf16 v[84:99], v[20:23], v[140:143], v[84:99]
    v_exp_f32 v62, v62
    v_exp_f32 v63, v63
    s_and_b32 s39, s7, 7
    s_lshl_b32 s39, s39, 1
    s_and_b32 s33, s89, 1
    s_add_u32 s39, s39, s33
    s_mul_i32 s39, s39, 88064
    s_lshr_b32 s33, s89, 1
    v_exp_f32 v64, v64
    v_exp_f32 v65, v65
    v_exp_f32 v66, v66
    v_exp_f32 v67, v67
    v_cvt_pk_bf16_f32 v144, v60, v61
    v_cvt_pk_bf16_f32 v145, v62, v63
    v_cvt_pk_bf16_f32 v146, v64, v65
    v_cvt_pk_bf16_f32 v147, v66, v67
    v_mfma_f32_32x32x16_bf16 v[52:67], v[16:19], v[8:11], v[116:131]
    s_waitcnt lgkmcnt(0)
    v_exp_f32 v36, v36
    ds_read_b128 v[16:19], v148 offset:5120
    v_exp_f32 v37, v37
    ds_read_b128 v[20:23], v149 offset:4096
    v_exp_f32 v38, v38
    buffer_load_dwordx4 v[208:211], v156, s[60:63], s37 offen offset:0 sc1
    v_exp_f32 v39, v39
    v_mfma_f32_32x32x16_bf16 v[84:99], v[24:27], v[144:147], v[84:99]
    v_exp_f32 v40, v40
    ds_read_b128 v[24:27], v149 offset:4608
    v_exp_f32 v41, v41
    s_mul_i32 s98, s33, 22528
    s_add_u32 s39, s39, s98
    s_add_u32 s39, s39, 27262976
    s_and_b32 s98, s33, 1
    s_lshl_b32 s98, s98, 4
    v_xor_b32 v242, s98, v2
    v_exp_f32 v42, v42
    v_exp_f32 v43, v43
    v_cvt_pk_bf16_f32 v132, v36, v37
    v_cvt_pk_bf16_f32 v133, v38, v39
    v_cvt_pk_bf16_f32 v134, v40, v41
    v_cvt_pk_bf16_f32 v135, v42, v43
    v_exp_f32 v44, v44
    buffer_load_dwordx4 v[212:215], v156, s[60:63], s37 offen offset:1024 sc1
    v_exp_f32 v45, v45
    v_mfma_f32_32x32x16_bf16 v[68:83], v[28:31], v[132:135], v[68:83]
    v_exp_f32 v46, v46
    v_exp_f32 v47, v47
    v_lshlrev_b32 v242, 4, v242
    s_cmp_eq_u32 s33, 3
    s_cselect_b32 s33, 0x40000000, 0
    v_exp_f32 v48, v48
    v_exp_f32 v49, v49
    v_exp_f32 v50, v50
    v_exp_f32 v51, v51
    v_cvt_pk_bf16_f32 v136, v44, v45
    v_cvt_pk_bf16_f32 v137, v46, v47
    v_cvt_pk_bf16_f32 v138, v48, v49
    v_cvt_pk_bf16_f32 v139, v50, v51
    v_mfma_f32_32x32x16_bf16 v[36:51], v[12:15], v[4:7], v[100:115]
    v_exp_f32 v52, v52
    v_exp_f32 v53, v53
    v_exp_f32 v54, v54
    buffer_load_dwordx4 v[216:219], v156, s[60:63], s37 offen offset:2048 sc1
    v_exp_f32 v55, v55
    v_mfma_f32_32x32x16_bf16 v[68:83], v[32:35], v[136:139], v[68:83]
    v_exp_f32 v56, v56
    v_exp_f32 v57, v57
    buffer_load_dwordx4 v[220:223], v156, s[60:63], s37 offen offset:3072 sc1
    s_add_u32 s37, s37, 4096
    v_exp_f32 v58, v58
    v_exp_f32 v59, v59
    v_cvt_pk_bf16_f32 v140, v52, v53
    v_cvt_pk_bf16_f32 v141, v54, v55
    v_cvt_pk_bf16_f32 v142, v56, v57
    v_cvt_pk_bf16_f32 v143, v58, v59
    v_exp_f32 v60, v60
    v_exp_f32 v61, v61
    v_mfma_f32_32x32x16_bf16 v[84:99], v[28:31], v[140:143], v[84:99]
    v_exp_f32 v62, v62
    v_exp_f32 v63, v63
    v_exp_f32 v64, v64
    v_exp_f32 v65, v65
    v_exp_f32 v66, v66
    v_exp_f32 v67, v67
    v_cvt_pk_bf16_f32 v144, v60, v61
    v_cvt_pk_bf16_f32 v145, v62, v63
    v_cvt_pk_bf16_f32 v146, v64, v65
    v_cvt_pk_bf16_f32 v147, v66, v67
    v_mfma_f32_32x32x16_bf16 v[52:67], v[12:15], v[8:11], v[116:131]
    v_add_u32 v148, 0x1000, v148
    v_add_u32 v149, v149, v151
    s_mov_b32 s31, 2
    s_cmp_eq_u32 s19, 0
    s_cselect_b32 s32, 13, 3
    s_cbranch_scc0 P3_LOWP
    s_setprio 1
P3_LOWP:
    s_cmp_ge_u32 s31, s32
    s_cbranch_scc1 P3_LEND
P3_LOOP:
    s_waitcnt lgkmcnt(0)
    v_exp_f32 v36, v36
    ds_read_b128 v[12:15], v148 offset:2048
    v_exp_f32 v37, v37
    ds_read_b128 v[28:31], v149 offset:1024
    v_exp_f32 v38, v38
    v_exp_f32 v39, v39
    v_mfma_f32_32x32x16_bf16 v[84:99], v[32:35], v[144:147], v[84:99]
    v_exp_f32 v40, v40
    ds_read_b128 v[32:35], v149 offset:1536
    v_exp_f32 v41, v41
    v_exp_f32 v42, v42
    v_exp_f32 v43, v43
    v_cvt_pk_bf16_f32 v132, v36, v37
    v_cvt_pk_bf16_f32 v133, v38, v39
    v_cvt_pk_bf16_f32 v134, v40, v41
    v_cvt_pk_bf16_f32 v135, v42, v43
    v_exp_f32 v44, v44
    v_exp_f32 v45, v45
    v_mfma_f32_32x32x16_bf16 v[68:83], v[20:23], v[132:135], v[68:83]
    v_exp_f32 v46, v46
    v_exp_f32 v47, v47
    v_exp_f32 v48, v48
    v_exp_f32 v49, v49
    v_exp_f32 v50, v50
    v_exp_f32 v51, v51
    v_cvt_pk_bf16_f32 v136, v44, v45
    v_cvt_pk_bf16_f32 v137, v46, v47
    v_cvt_pk_bf16_f32 v138, v48, v49
    v_cvt_pk_bf16_f32 v139, v50, v51
    v_mfma_f32_32x32x16_bf16 v[36:51], v[16:19], v[4:7], v[100:115]
    v_exp_f32 v52, v52
    v_exp_f32 v53, v53
    v_exp_f32 v54, v54
    v_exp_f32 v55, v55
    v_mfma_f32_32x32x16_bf16 v[68:83], v[24:27], v[136:139], v[68:83]
    v_exp_f32 v56, v56
    v_exp_f32 v57, v57
    v_exp_f32 v58, v58
    v_exp_f32 v59, v59
    v_cvt_pk_bf16_f32 v140, v52, v53
    v_cvt_pk_bf16_f32 v141, v54, v55
    v_cvt_pk_bf16_f32 v142, v56, v57
    v_cvt_pk_bf16_f32 v143, v58, v59
    v_exp_f32 v60, v60
    v_exp_f32 v61, v61
    v_mfma_f32_32x32x16_bf16 v[84:99], v[20:23], v[140:143], v[84:99]
    v_exp_f32 v62, v62
    v_exp_f32 v63, v63
    v_exp_f32 v64, v64
    v_exp_f32 v65, v65
    v_exp_f32 v66, v66
    v_exp_f32 v67, v67
    v_cvt_pk_bf16_f32 v144, v60, v61
    v_cvt_pk_bf16_f32 v145, v62, v63
    v_cvt_pk_bf16_f32 v146, v64, v65
    v_cvt_pk_bf16_f32 v147, v66, v67
    v_mfma_f32_32x32x16_bf16 v[52:67], v[16:19], v[8:11], v[116:131]
    s_waitcnt lgkmcnt(0)
    v_exp_f32 v36, v36
    ds_read_b128 v[16:19], v148 offset:3072
    v_exp_f32 v37, v37
    ds_read_b128 v[20:23], v149 offset:2048
    v_exp_f32 v38, v38
    v_exp_f32 v39, v39
    v_mfma_f32_32x32x16_bf16 v[84:99], v[24:27], v[144:147], v[84:99]
    v_exp_f32 v40, v40
    ds_read_b128 v[24:27], v149 offset:2560
    v_exp_f32 v41, v41
    v_exp_f32 v42, v42
    v_exp_f32 v43, v43
    v_cvt_pk_bf16_f32 v132, v36, v37
    v_cvt_pk_bf16_f32 v133, v38, v39
    v_cvt_pk_bf16_f32 v134, v40, v41
    v_cvt_pk_bf16_f32 v135, v42, v43
    v_exp_f32 v44, v44
    v_exp_f32 v45, v45
    v_mfma_f32_32x32x16_bf16 v[68:83], v[28:31], v[132:135], v[68:83]
    v_exp_f32 v46, v46
    v_exp_f32 v47, v47
    v_exp_f32 v48, v48
    v_exp_f32 v49, v49
    v_exp_f32 v50, v50
    v_exp_f32 v51, v51
    v_cvt_pk_bf16_f32 v136, v44, v45
    v_cvt_pk_bf16_f32 v137, v46, v47
    v_cvt_pk_bf16_f32 v138, v48, v49
    v_cvt_pk_bf16_f32 v139, v50, v51
    v_mfma_f32_32x32x16_bf16 v[36:51], v[12:15], v[4:7], v[100:115]
    v_exp_f32 v52, v52
    v_exp_f32 v53, v53
    v_exp_f32 v54, v54
    v_exp_f32 v55, v55
    v_mfma_f32_32x32x16_bf16 v[68:83], v[32:35], v[136:139], v[68:83]
    v_exp_f32 v56, v56
    v_exp_f32 v57, v57
    v_exp_f32 v58, v58
    v_exp_f32 v59, v59
    v_cvt_pk_bf16_f32 v140, v52, v53
    v_cvt_pk_bf16_f32 v141, v54, v55
    v_cvt_pk_bf16_f32 v142, v56, v57
    v_cvt_pk_bf16_f32 v143, v58, v59
    v_exp_f32 v60, v60
    v_exp_f32 v61, v61
    v_mfma_f32_32x32x16_bf16 v[84:99], v[28:31], v[140:143], v[84:99]
    v_exp_f32 v62, v62
    v_exp_f32 v63, v63
    v_exp_f32 v64, v64
    v_exp_f32 v65, v65
    v_exp_f32 v66, v66
    v_exp_f32 v67, v67
    v_cvt_pk_bf16_f32 v144, v60, v61
    v_cvt_pk_bf16_f32 v145, v62, v63
    v_cvt_pk_bf16_f32 v146, v64, v65
    v_cvt_pk_bf16_f32 v147, v66, v67
    v_mfma_f32_32x32x16_bf16 v[52:67], v[12:15], v[8:11], v[116:131]
    s_waitcnt lgkmcnt(0)
    v_exp_f32 v36, v36
    ds_read_b128 v[12:15], v148 offset:4096
    v_exp_f32 v37, v37
    ds_read_b128 v[28:31], v149 offset:3072
    v_exp_f32 v38, v38
    v_exp_f32 v39, v39
    v_mfma_f32_32x32x16_bf16 v[84:99], v[32:35], v[144:147], v[84:99]
    v_exp_f32 v40, v40
    ds_read_b128 v[32:35], v149 offset:3584
    v_exp_f32 v41, v41
    v_exp_f32 v42, v42
    v_exp_f32 v43, v43
    v_cvt_pk_bf16_f32 v132, v36, v37
    v_cvt_pk_bf16_f32 v133, v38, v39
    v_cvt_pk_bf16_f32 v134, v40, v41
    v_cvt_pk_bf16_f32 v135, v42, v43
    v_exp_f32 v44, v44
    v_exp_f32 v45, v45
    v_mfma_f32_32x32x16_bf16 v[68:83], v[20:23], v[132:135], v[68:83]
    v_exp_f32 v46, v46
    v_exp_f32 v47, v47
    v_exp_f32 v48, v48
    v_exp_f32 v49, v49
    v_exp_f32 v50, v50
    v_exp_f32 v51, v51
    v_cvt_pk_bf16_f32 v136, v44, v45
    v_cvt_pk_bf16_f32 v137, v46, v47
    v_cvt_pk_bf16_f32 v138, v48, v49
    v_cvt_pk_bf16_f32 v139, v50, v51
    v_mfma_f32_32x32x16_bf16 v[36:51], v[16:19], v[4:7], v[100:115]
    v_exp_f32 v52, v52
    v_exp_f32 v53, v53
    v_exp_f32 v54, v54
    v_exp_f32 v55, v55
    v_mfma_f32_32x32x16_bf16 v[68:83], v[24:27], v[136:139], v[68:83]
    v_exp_f32 v56, v56
    v_exp_f32 v57, v57
    v_exp_f32 v58, v58
    v_exp_f32 v59, v59
    v_cvt_pk_bf16_f32 v140, v52, v53
    v_cvt_pk_bf16_f32 v141, v54, v55
    v_cvt_pk_bf16_f32 v142, v56, v57
    v_cvt_pk_bf16_f32 v143, v58, v59
    v_exp_f32 v60, v60
    v_exp_f32 v61, v61
    v_mfma_f32_32x32x16_bf16 v[84:99], v[20:23], v[140:143], v[84:99]
    v_exp_f32 v62, v62
    v_exp_f32 v63, v63
    v_exp_f32 v64, v64
    v_exp_f32 v65, v65
    v_exp_f32 v66, v66
    v_exp_f32 v67, v67
    v_cvt_pk_bf16_f32 v144, v60, v61
    v_cvt_pk_bf16_f32 v145, v62, v63
    v_cvt_pk_bf16_f32 v146, v64, v65
    v_cvt_pk_bf16_f32 v147, v66, v67
    v_mfma_f32_32x32x16_bf16 v[52:67], v[16:19], v[8:11], v[116:131]
    s_waitcnt lgkmcnt(0)
    v_exp_f32 v36, v36
    ds_read_b128 v[16:19], v148 offset:5120
    v_exp_f32 v37, v37
    ds_read_b128 v[20:23], v149 offset:4096
    v_exp_f32 v38, v38
    v_exp_f32 v39, v39
    v_mfma_f32_32x32x16_bf16 v[84:99], v[24:27], v[144:147], v[84:99]
    v_exp_f32 v40, v40
    ds_read_b128 v[24:27], v149 offset:4608
    v_exp_f32 v41, v41
    v_exp_f32 v42, v42
    v_exp_f32 v43, v43
    v_cvt_pk_bf16_f32 v132, v36, v37
    v_cvt_pk_bf16_f32 v133, v38, v39
    v_cvt_pk_bf16_f32 v134, v40, v41
    v_cvt_pk_bf16_f32 v135, v42, v43
    v_exp_f32 v44, v44
    v_exp_f32 v45, v45
    v_mfma_f32_32x32x16_bf16 v[68:83], v[28:31], v[132:135], v[68:83]
    v_exp_f32 v46, v46
    v_exp_f32 v47, v47
    v_exp_f32 v48, v48
    v_exp_f32 v49, v49
    v_exp_f32 v50, v50
    v_exp_f32 v51, v51
    v_cvt_pk_bf16_f32 v136, v44, v45
    v_cvt_pk_bf16_f32 v137, v46, v47
    v_cvt_pk_bf16_f32 v138, v48, v49
    v_cvt_pk_bf16_f32 v139, v50, v51
    v_mfma_f32_32x32x16_bf16 v[36:51], v[12:15], v[4:7], v[100:115]
    v_exp_f32 v52, v52
    v_exp_f32 v53, v53
    v_exp_f32 v54, v54
    v_exp_f32 v55, v55
    v_mfma_f32_32x32x16_bf16 v[68:83], v[32:35], v[136:139], v[68:83]
    v_exp_f32 v56, v56
    v_exp_f32 v57, v57
    v_exp_f32 v58, v58
    v_exp_f32 v59, v59
    v_cvt_pk_bf16_f32 v140, v52, v53
    v_cvt_pk_bf16_f32 v141, v54, v55
    v_cvt_pk_bf16_f32 v142, v56, v57
    v_cvt_pk_bf16_f32 v143, v58, v59
    v_exp_f32 v60, v60
    v_exp_f32 v61, v61
    v_mfma_f32_32x32x16_bf16 v[84:99], v[28:31], v[140:143], v[84:99]
    v_exp_f32 v62, v62
    v_exp_f32 v63, v63
    v_exp_f32 v64, v64
    v_exp_f32 v65, v65
    v_exp_f32 v66, v66
    v_exp_f32 v67, v67
    v_cvt_pk_bf16_f32 v144, v60, v61
    v_cvt_pk_bf16_f32 v145, v62, v63
    v_cvt_pk_bf16_f32 v146, v64, v65
    v_cvt_pk_bf16_f32 v147, v66, v67
    v_mfma_f32_32x32x16_bf16 v[52:67], v[12:15], v[8:11], v[116:131]
    v_add_u32 v148, 0x1000, v148
    v_add_u32 v149, v149, v151
    s_add_u32 s31, s31, 1
    s_cmp_lt_u32 s31, s32
    s_cbranch_scc1 P3_LOOP
P3_LEND:
    s_setprio 0
    s_waitcnt lgkmcnt(0)
    v_mfma_f32_32x32x16_bf16 v[84:99], v[32:35], v[144:147], v[84:99]
    s_and_b32 s22, s89, 3
    s_lshl_b32 s22, s22, 1
    s_xor_b32 s23, s19, 1
    s_add_u32 s23, s23, s22
    s_mul_i32 s23, s23, 2304
    s_add_u32 s23, s23, 136192
    v_lshlrev_b32 v152, 2, v2
    v_add_u32 v153, s23, v152
    s_add_u32 s22, s22, s19
    s_mul_i32 s22, s22, 2304
    s_add_u32 s22, s22, 136192
    v_add_u32 v154, s22, v152
    ds_write_b32 v153, v84 offset:0
    ds_write_b32 v153, v85 offset:256
    ds_write_b32 v153, v86 offset:512
    ds_write_b32 v153, v87 offset:768
    ds_write_b32 v153, v88 offset:1024
    ds_write_b32 v153, v89 offset:1280
    ds_write_b32 v153, v90 offset:1536
    ds_write_b32 v153, v91 offset:1792
    ds_write_b32 v153, v92 offset:2048
    s_waitcnt lgkmcnt(0)
    s_barrier
    ds_read_b32 v36, v154 offset:0
    ds_read_b32 v37, v154 offset:256
    ds_read_b32 v38, v154 offset:512
    ds_read_b32 v39, v154 offset:768
    ds_read_b32 v40, v154 offset:1024
    ds_read_b32 v41, v154 offset:1280
    ds_read_b32 v42, v154 offset:1536
    ds_read_b32 v43, v154 offset:1792
    ds_read_b32 v44, v154 offset:2048
    s_waitcnt lgkmcnt(0)
    v_add_f32 v68, v68, v36
    v_add_f32 v69, v69, v37
    v_add_f32 v70, v70, v38
    v_add_f32 v71, v71, v39
    v_add_f32 v72, v72, v40
    v_add_f32 v73, v73, v41
    v_add_f32 v74, v74, v42
    v_add_f32 v75, v75, v43
    v_add_f32 v76, v76, v44
    v_mov_b32 v155, v76
    s_nop 1
    v_permlane32_swap_b32 v155, v76
    v_mul_f32 v152, 0, v155
    v_fmac_f32 v152, 0, v68
    v_fmac_f32 v152, 0, v69
    v_fmac_f32 v152, 0, v70
    v_fmac_f32 v152, 0, v71
    v_fmac_f32 v152, 0, v72
    v_fmac_f32 v152, 0, v73
    v_fmac_f32 v152, 0, v74
    v_fmac_f32 v152, 0, v75
    v_mov_b32 v153, 0x5f800000
    v_cmp_u_f32 vcc, v152, v152
    v_cmp_nlt_f32 s[34:35], v155, v153
    s_nop 1
    s_or_b64 s[34:35], vcc, s[34:35]
    s_cbranch_scc0 P3_FIN
    v_mov_b32 v148, v3
    v_mov_b32 v152, 0xff800000
    s_mov_b32 s31, 0
P3_MAXL:
    ds_read_b128 v[12:15], v148
    s_waitcnt lgkmcnt(0)
    v_mfma_f32_32x32x16_bf16 v[36:51], v[12:15], v[4:7], 0
    v_add_u32 v148, 0x400, v148
    s_nop 10
    v_max3_f32 v152, v152, v36, v37
    v_max3_f32 v152, v152, v38, v39
    v_max3_f32 v152, v152, v40, v41
    v_max3_f32 v152, v152, v42, v43
    v_max3_f32 v152, v152, v44, v45
    v_max3_f32 v152, v152, v46, v47
    v_max3_f32 v152, v152, v48, v49
    v_max3_f32 v152, v152, v50, v51
    s_add_u32 s31, s31, 1
    s_cmp_lt_u32 s31, 64
    s_cbranch_scc1 P3_MAXL
    v_mov_b32 v153, v152
    s_nop 1
    v_permlane32_swap_b32 v152, v153
    v_max_f32 v152, v152, v153
    v_sub_f32 v100, 0, v152
    v_sub_f32 v101, 0, v152
    v_sub_f32 v102, 0, v152
    v_sub_f32 v103, 0, v152
    v_sub_f32 v104, 0, v152
    v_sub_f32 v105, 0, v152
    v_sub_f32 v106, 0, v152
    v_sub_f32 v107, 0, v152
    v_sub_f32 v108, 0, v152
    v_sub_f32 v109, 0, v152
    v_sub_f32 v110, 0, v152
    v_sub_f32 v111, 0, v152
    v_sub_f32 v112, 0, v152
    v_sub_f32 v113, 0, v152
    v_sub_f32 v114, 0, v152
    v_sub_f32 v115, 0, v152
    v_mov_b32 v68, 0
    v_mov_b32 v69, 0
    v_mov_b32 v70, 0
    v_mov_b32 v71, 0
    v_mov_b32 v72, 0
    v_mov_b32 v73, 0
    v_mov_b32 v74, 0
    v_mov_b32 v75, 0
    v_mov_b32 v76, 0
    v_mov_b32 v77, 0
    v_mov_b32 v78, 0
    v_mov_b32 v79, 0
    v_mov_b32 v80, 0
    v_mov_b32 v81, 0
    v_mov_b32 v82, 0
    v_mov_b32 v83, 0
    v_mov_b32 v148, v3
    s_mul_i32 s26, s19, 53248
    v_lshrrev_b32 v153, 12, v151
    v_mul_lo_u32 v153, v153, s26
    v_sub_u32 v149, v150, v153
    v_lshrrev_b32 v154, 2, v151
    s_mov_b32 s31, 0
P3_FBL:
    ds_read_b128 v[12:15], v148
    ds_read_b128 v[20:23], v149
    ds_read_b128 v[24:27], v149 offset:512
    s_waitcnt lgkmcnt(0)
    v_mfma_f32_32x32x16_bf16 v[36:51], v[12:15], v[4:7], v[100:115]
    v_add_u32 v148, 0x400, v148
    v_add_u32 v149, v149, v154
    s_nop 9
    v_exp_f32 v36, v36
    v_exp_f32 v37, v37
    v_exp_f32 v38, v38
    v_exp_f32 v39, v39
    v_exp_f32 v40, v40
    v_exp_f32 v41, v41
    v_exp_f32 v42, v42
    v_exp_f32 v43, v43
    v_exp_f32 v44, v44
    v_exp_f32 v45, v45
    v_exp_f32 v46, v46
    v_exp_f32 v47, v47
    v_exp_f32 v48, v48
    v_exp_f32 v49, v49
    v_exp_f32 v50, v50
    v_exp_f32 v51, v51
    v_cvt_pk_bf16_f32 v132, v36, v37
    v_cvt_pk_bf16_f32 v133, v38, v39
    v_cvt_pk_bf16_f32 v134, v40, v41
    v_cvt_pk_bf16_f32 v135, v42, v43
    v_cvt_pk_bf16_f32 v136, v44, v45
    v_cvt_pk_bf16_f32 v137, v46, v47
    v_cvt_pk_bf16_f32 v138, v48, v49
    v_cvt_pk_bf16_f32 v139, v50, v51
    v_mfma_f32_32x32x16_bf16 v[68:83], v[20:23], v[132:135], v[68:83]
    s_nop 0
    v_mfma_f32_32x32x16_bf16 v[68:83], v[24:27], v[136:139], v[68:83]
    s_add_u32 s31, s31, 1
    s_cmp_lt_u32 s31, 64
    s_nop 7
    s_cbranch_scc1 P3_FBL
    s_nop 7
    v_mov_b32 v155, v76
    s_nop 1
    v_permlane32_swap_b32 v155, v76
P3_FIN:
    v_rcp_f32 v152, v155
    s_nop 0
    v_mul_f32 v68, v68, v152
    v_mul_f32 v69, v69, v152
    v_mul_f32 v70, v70, v152
    v_mul_f32 v71, v71, v152
    v_mul_f32 v72, v72, v152
    v_mul_f32 v73, v73, v152
    v_mul_f32 v74, v74, v152
    v_mul_f32 v75, v75, v152
    v_cvt_pk_bf16_f32 v132, v68, v69
    v_cvt_pk_bf16_f32 v133, v70, v71
    v_cvt_pk_bf16_f32 v134, v72, v73
    v_cvt_pk_bf16_f32 v135, v74, v75
    buffer_store_dwordx4 v[132:135], v3, s[60:63], s18 offen sc1
    s_waitcnt vmcnt(0) lgkmcnt(0)
    s_barrier
    s_cmp_eq_u32 s89, 0
    s_cbranch_scc0 PUB_16
    s_cmp_lg_u32 s88, 0
    s_cbranch_scc1 NONCE_17_OK
    s_waitcnt vmcnt(0)
    v_readfirstlane_b32 s88, v249
    s_nop 1
    s_cmp_lg_u32 s88, 0
    s_cbranch_scc1 NONCE_17_OK
    s_mov_b32 s98, 0
NONCE_17_L:
    v_mov_b32 v250, 0
    global_load_dword v251, v250, s[84:85] sc1
    s_waitcnt vmcnt(0)
    v_readfirstlane_b32 s88, v251
    s_add_u32 s98, s98, 1
    s_cmp_gt_u32 s98, 0x4000
    s_cbranch_scc1 NONCE_17_OK
    s_cmp_eq_u32 s88, 0
    s_cbranch_scc1 NONCE_17_L
NONCE_17_OK:
    s_lshl_b32 s98, s30, 7
    v_mov_b32 v250, s98
    v_mov_b32 v251, s88
    s_mov_b64 exec, 1
    buffer_store_dword v251, v250, s[92:95], 0 offen sc1
    s_mov_b64 exec, -1
PUB_16:
    s_cmp_eq_u32 s89, 0
    s_cbranch_scc1 WAIT_18_W0
    buffer_load_dwordx4 v[64:67], v242, s[60:63], s39 offen offset:0 sc1
    buffer_load_dwordx4 v[68:71], v242, s[60:63], s39 offen offset:1024 sc1
    buffer_load_dwordx4 v[72:75], v242, s[60:63], s39 offen offset:2048 sc1
    buffer_load_dwordx4 v[76:79], v242, s[60:63], s39 offen offset:3072 sc1
    s_add_u32 s39, s39, 4096
    buffer_load_dwordx4 v[80:83], v242, s[60:63], s39 offen offset:0 sc1
    buffer_load_dwordx4 v[84:87], v242, s[60:63], s39 offen offset:1024 sc1
    buffer_load_dwordx4 v[88:91], v242, s[60:63], s39 offen offset:2048 sc1
    buffer_load_dwordx4 v[92:95], v242, s[60:63], s39 offen offset:3072 sc1
    s_add_u32 s39, s39, 4096
    s_branch WAIT_18_B
WAIT_18_W0:
    s_cmp_lg_u32 s88, 0
    s_cbranch_scc1 NONCE_19_OK
    s_waitcnt vmcnt(0)
    v_readfirstlane_b32 s88, v249
    s_nop 1
    s_cmp_lg_u32 s88, 0
    s_cbranch_scc1 NONCE_19_OK
    s_mov_b32 s98, 0
NONCE_19_L:
    v_mov_b32 v250, 0
    global_load_dword v251, v250, s[84:85] sc1
    s_waitcnt vmcnt(0)
    v_readfirstlane_b32 s88, v251
    s_add_u32 s98, s98, 1
    s_cmp_gt_u32 s98, 0x4000
    s_cbranch_scc1 NONCE_19_OK
    s_cmp_eq_u32 s88, 0
    s_cbranch_scc1 NONCE_19_L
NONCE_19_OK:
    v_add_u32 v250, s47, v2
    s_lshr_b32 s98, s51, 2
    s_lshl_b32 s98, s98, 4
    v_mov_b32 v253, s98
    s_add_u32 s98, s51, 2
    s_lshr_b32 s98, s98, 2
    s_lshl_b32 s98, s98, 4
    v_mov_b32 v252, s98
    v_cmp_le_u32 vcc, 48, v2
    s_nop 1
    v_cndmask_b32 v252, v253, v252, vcc
    v_and_b32 v253, 15, v2
    v_add_u32 v252, v252, v253
    v_add_u32 v252, 1408, v252
    v_cmp_le_u32 vcc, 32, v2
    s_nop 1
    v_cndmask_b32 v250, v250, v252, vcc
    v_lshlrev_b32 v250, 7, v250
    s_mov_b32 s98, 0
    buffer_load_dword v251, v250, s[92:95], 0 offen sc1
WAIT_18_L:
    buffer_load_dword v254, v250, s[92:95], 0 offen sc1
    s_waitcnt vmcnt(1)
    v_cmp_ne_u32 vcc, s88, v251
    s_nop 1
    s_cmp_eq_u64 vcc, 0
    s_cbranch_scc1 WAIT_18_E
    buffer_load_dword v251, v250, s[92:95], 0 offen sc1
    s_add_u32 s98, s98, 1
    s_waitcnt vmcnt(1)
    v_cmp_ne_u32 vcc, s88, v254
    s_nop 1
    s_cmp_eq_u64 vcc, 0
    s_cbranch_scc1 WAIT_18_E
    s_cmp_gt_u32 s98, 0x2000
    s_cbranch_scc0 WAIT_18_L
WAIT_18_E:
    buffer_load_dwordx4 v[64:67], v242, s[60:63], s39 offen offset:0 sc1
    buffer_load_dwordx4 v[68:71], v242, s[60:63], s39 offen offset:1024 sc1
    buffer_load_dwordx4 v[72:75], v242, s[60:63], s39 offen offset:2048 sc1
    buffer_load_dwordx4 v[76:79], v242, s[60:63], s39 offen offset:3072 sc1
    s_add_u32 s39, s39, 4096
    buffer_load_dwordx4 v[80:83], v242, s[60:63], s39 offen offset:0 sc1
    buffer_load_dwordx4 v[84:87], v242, s[60:63], s39 offen offset:1024 sc1
    buffer_load_dwordx4 v[88:91], v242, s[60:63], s39 offen offset:2048 sc1
    buffer_load_dwordx4 v[92:95], v242, s[60:63], s39 offen offset:3072 sc1
    s_add_u32 s39, s39, 4096
WAIT_18_B:
    s_barrier
    s_lshl_b32 m0, s89, 12
    s_nop 0
    buffer_load_dwordx4 v3, s[60:63], s48 offen offset:0 sc1 lds
    buffer_load_dwordx4 v3, s[60:63], s48 offen offset:1024 sc1 lds
    buffer_load_dwordx4 v3, s[60:63], s48 offen offset:2048 sc1 lds
    buffer_load_dwordx4 v3, s[60:63], s48 offen offset:3072 sc1 lds
    s_lshl_b32 s25, s19, 14
    v_add_u32 v9, s25, v3
    s_lshl_b32 s25, s89, 11
    s_add_u32 s25, s25, 32768
    v_add_u32 v10, s25, v3
    s_xor_b32 s25, s89, 4
    s_lshl_b32 s25, s25, 11
    s_add_u32 s25, s25, 32768
    v_add_u32 v11, s25, v3
    v_lshlrev_b32 v48, 16, v224
    v_and_b32 v49, 0xffff0000, v224
    v_lshlrev_b32 v50, 16, v225
    v_and_b32 v51, 0xffff0000, v225
    v_lshlrev_b32 v52, 16, v226
    v_and_b32 v53, 0xffff0000, v226
    v_lshlrev_b32 v54, 16, v227
    v_and_b32 v55, 0xffff0000, v227
    s_lshl_b32 s25, s89, 8
    s_add_u32 s25, s25, 150528
    v_lshlrev_b32 v14, 3, v240
    v_add_u32 v15, s25, v14
    s_waitcnt vmcnt(0)
    s_barrier
    ds_read_b128 v[32:35], v9 offset:0
    ds_read_b128 v[36:39], v9 offset:1024
    ds_read_b128 v[40:43], v9 offset:2048
    s_add_u32 m0, s59, 0
    s_add_u32 s27, s58, 0
    s_waitcnt lgkmcnt(2)
    v_mfma_f32_32x32x16_bf16 v[16:31], v[160:163], v[32:35], 0
    buffer_load_dwordx4 v3, s[60:63], s27 offen sc1 lds
    ds_read_b128 v[44:47], v9 offset:3072
    s_add_u32 m0, s59, 1024
    s_add_u32 s27, s58, 33792
    s_waitcnt lgkmcnt(2)
    v_mfma_f32_32x32x16_bf16 v[16:31], v[164:167], v[36:39], v[16:31]
    buffer_load_dwordx4 v3, s[60:63], s27 offen sc1 lds
    ds_read_b128 v[32:35], v9 offset:4096
    s_add_u32 m0, s59, 2048
    s_add_u32 s27, s58, 67584
    s_waitcnt lgkmcnt(2)
    v_mfma_f32_32x32x16_bf16 v[16:31], v[168:171], v[40:43], v[16:31]
    buffer_load_dwordx4 v3, s[60:63], s27 offen sc1 lds
    ds_read_b128 v[36:39], v9 offset:5120
    s_add_u32 m0, s59, 24576
    s_add_u32 s27, s58, 8192
    s_waitcnt lgkmcnt(2)
    v_mfma_f32_32x32x16_bf16 v[16:31], v[172:175], v[44:47], v[16:31]
    buffer_load_dwordx4 v3, s[60:63], s27 offen sc1 lds
    ds_read_b128 v[40:43], v9 offset:6144
    s_add_u32 m0, s59, 25600
    s_add_u32 s27, s58, 41984
    s_waitcnt lgkmcnt(2)
    v_mfma_f32_32x32x16_bf16 v[16:31], v[176:179], v[32:35], v[16:31]
    buffer_load_dwordx4 v3, s[60:63], s27 offen sc1 lds
    ds_read_b128 v[44:47], v9 offset:7168
    s_add_u32 m0, s59, 26624
    s_add_u32 s27, s58, 75776
    s_waitcnt lgkmcnt(2)
    v_mfma_f32_32x32x16_bf16 v[16:31], v[180:183], v[36:39], v[16:31]
    buffer_load_dwordx4 v3, s[60:63], s27 offen sc1 lds
    ds_read_b128 v[32:35], v9 offset:8192
    s_add_u32 m0, s59, 49152
    s_add_u32 s27, s58, 16384
    s_waitcnt lgkmcnt(2)
    v_mfma_f32_32x32x16_bf16 v[16:31], v[184:187], v[40:43], v[16:31]
    buffer_load_dwordx4 v3, s[60:63], s27 offen sc1 lds
    ds_read_b128 v[36:39], v9 offset:9216
    s_add_u32 m0, s59, 50176
    s_add_u32 s27, s58, 50176
    s_waitcnt lgkmcnt(2)
    v_mfma_f32_32x32x16_bf16 v[16:31], v[188:191], v[44:47], v[16:31]
    buffer_load_dwordx4 v3, s[60:63], s27 offen sc1 lds
    ds_read_b128 v[40:43], v9 offset:10240
    s_add_u32 m0, s59, 51200
    s_add_u32 s27, s58, 83968
    s_waitcnt lgkmcnt(2)
    v_mfma_f32_32x32x16_bf16 v[16:31], v[192:195], v[32:35], v[16:31]
    buffer_load_dwordx4 v3, s[60:63], s27 offen sc1 lds
    ds_read_b128 v[44:47], v9 offset:11264
    s_add_u32 m0, s59, 73728
    s_add_u32 s27, s58, 24576
    s_waitcnt lgkmcnt(2)
    v_mfma_f32_32x32x16_bf16 v[16:31], v[196:199], v[36:39], v[16:31]
    buffer_load_dwordx4 v3, s[60:63], s27 offen sc1 lds
    ds_read_b128 v[32:35], v9 offset:12288
    s_add_u32 m0, s59, 74752
    s_add_u32 s27, s58, 58368
    s_waitcnt lgkmcnt(2)
    v_mfma_f32_32x32x16_bf16 v[16:31], v[200:203], v[40:43], v[16:31]
    buffer_load_dwordx4 v3, s[60:63], s27 offen sc1 lds
    ds_read_b128 v[36:39], v9 offset:13312
    s_add_u32 m0, s59, 75776
    s_add_u32 s27, s58, 92160
    s_waitcnt lgkmcnt(2)
    v_mfma_f32_32x32x16_bf16 v[16:31], v[204:207], v[44:47], v[16:31]
    buffer_load_dwordx4 v3, s[60:63], s27 offen sc1 lds
    ds_read_b128 v[40:43], v9 offset:14336
    s_waitcnt lgkmcnt(2)
    v_mfma_f32_32x32x16_bf16 v[16:31], v[208:211], v[32:35], v[16:31]
    ds_read_b128 v[44:47], v9 offset:15360
    s_waitcnt lgkmcnt(2)
    v_mfma_f32_32x32x16_bf16 v[16:31], v[212:215], v[36:39], v[16:31]
    s_waitcnt lgkmcnt(1)
    v_mfma_f32_32x32x16_bf16 v[16:31], v[216:219], v[40:43], v[16:31]
    s_waitcnt lgkmcnt(0)
    v_mfma_f32_32x32x16_bf16 v[16:31], v[220:223], v[44:47], v[16:31]
    s_nop 11
    ds_write_b128 v10, v[24:27]
    ds_write_b128 v10, v[28:31] offset:1024
    s_waitcnt lgkmcnt(0)
    s_barrier
    ds_read_b128 v[56:59], v11
    ds_read_b128 v[60:63], v11 offset:1024
    s_waitcnt lgkmcnt(0)
    v_add_f32 v16, v16, v56
    v_add_f32 v17, v17, v57
    v_add_f32 v18, v18, v58
    v_add_f32 v19, v19, v59
    v_add_f32 v20, v20, v60
    v_add_f32 v21, v21, v61
    v_add_f32 v22, v22, v62
    v_add_f32 v23, v23, v63
    v_fma_f32 v16, v16, v228, v48
    v_fma_f32 v17, v17, v229, v49
    v_fma_f32 v18, v18, v230, v50
    v_fma_f32 v19, v19, v231, v51
    v_fma_f32 v20, v20, v232, v52
    v_fma_f32 v21, v21, v233, v53
    v_fma_f32 v22, v22, v234, v54
    v_fma_f32 v23, v23, v235, v55
    v_cvt_pk_bf16_f32 v56, v16, v17
    v_cvt_pk_bf16_f32 v57, v18, v19
    v_cvt_pk_bf16_f32 v58, v20, v21
    v_cvt_pk_bf16_f32 v59, v22, v23
    buffer_store_dwordx4 v[56:59], v3, s[60:63], s54 offen sc1
    v_lshlrev_b32 v48, 16, v56
    v_and_b32 v49, 0xffff0000, v56
    v_lshlrev_b32 v50, 16, v57
    v_and_b32 v51, 0xffff0000, v57
    v_lshlrev_b32 v52, 16, v58
    v_and_b32 v53, 0xffff0000, v58
    v_lshlrev_b32 v54, 16, v59
    v_and_b32 v55, 0xffff0000, v59
    v_add_f32 v12, v48, v49
    v_mul_f32 v13, v48, v48
    v_fmac_f32 v13, v49, v49
    v_add_f32 v12, v12, v50
    v_fmac_f32 v13, v50, v50
    v_add_f32 v12, v12, v51
    v_fmac_f32 v13, v51, v51
    v_add_f32 v12, v12, v52
    v_fmac_f32 v13, v52, v52
    v_add_f32 v12, v12, v53
    v_fmac_f32 v13, v53, v53
    v_add_f32 v12, v12, v54
    v_fmac_f32 v13, v54, v54
    v_add_f32 v12, v12, v55
    v_fmac_f32 v13, v55, v55
    v_mov_b32 v16, v12
    v_mov_b32 v17, v13
    s_nop 0
    v_permlane32_swap_b32 v12, v16
    v_permlane32_swap_b32 v13, v17
    v_add_f32 v12, v12, v16
    v_add_f32 v13, v13, v17
    ds_write_b64 v15, v[12:13]
    s_waitcnt lgkmcnt(0)
    s_barrier
    s_cmp_eq_u32 s89, 0
    s_cbranch_scc0 P4_PUB
    v_add_u32 v15, 150528, v14
    ds_read_b64 v[32:33], v15 offset:0
    ds_read_b64 v[34:35], v15 offset:256
    ds_read_b64 v[36:37], v15 offset:512
    ds_read_b64 v[38:39], v15 offset:768
    ds_read_b64 v[40:41], v15 offset:1024
    ds_read_b64 v[42:43], v15 offset:1280
    ds_read_b64 v[44:45], v15 offset:1536
    ds_read_b64 v[46:47], v15 offset:1792
    s_waitcnt lgkmcnt(0)
    v_add_f32 v32, v32, v40
    v_add_f32 v33, v33, v41
    v_add_f32 v34, v34, v42
    v_add_f32 v35, v35, v43
    v_add_f32 v36, v36, v44
    v_add_f32 v37, v37, v45
    v_add_f32 v38, v38, v46
    v_add_f32 v39, v39, v47
    v_add_f32 v32, v32, v36
    v_add_f32 v33, v33, v37
    v_add_f32 v34, v34, v38
    v_add_f32 v35, v35, v39
    v_add_f32 v32, v32, v34
    v_add_f32 v33, v33, v35
    buffer_store_dwordx2 v[32:33], v14, s[60:63], s55 offen sc1
P4_PUB:
    s_waitcnt vmcnt(0) lgkmcnt(0)
    s_barrier
    s_cmp_eq_u32 s89, 0
    s_cbranch_scc0 PUB_20
    s_cmp_lg_u32 s88, 0
    s_cbranch_scc1 NONCE_21_OK
    s_waitcnt vmcnt(0)
    v_readfirstlane_b32 s88, v249
    s_nop 1
    s_cmp_lg_u32 s88, 0
    s_cbranch_scc1 NONCE_21_OK
    s_mov_b32 s98, 0
NONCE_21_L:
    v_mov_b32 v250, 0
    global_load_dword v251, v250, s[84:85] sc1
    s_waitcnt vmcnt(0)
    v_readfirstlane_b32 s88, v251
    s_add_u32 s98, s98, 1
    s_cmp_gt_u32 s98, 0x4000
    s_cbranch_scc1 NONCE_21_OK
    s_cmp_eq_u32 s88, 0
    s_cbranch_scc1 NONCE_21_L
NONCE_21_OK:
    s_lshl_b32 s98, s56, 7
    v_mov_b32 v250, s98
    v_mov_b32 v251, s88
    s_mov_b64 exec, 1
    buffer_store_dword v251, v250, s[92:95], 0 offen sc1
    s_mov_b64 exec, -1
PUB_20:
    s_mul_i32 s26, s89, 0x5556
    s_lshr_b32 s26, s26, 16
    s_mul_i32 s26, s26, 3
    s_sub_u32 s26, s89, s26
    s_add_u32 s27, s51, s26
    s_lshl_b32 s27, s27, 4
    v_and_b32 v36, 15, v2
    v_bfe_u32 v37, v2, 4, 1
    v_mul_u32_u24 v37, 1376, v37
    v_add3_u32 v36, v36, v37, s27
    v_lshlrev_b32 v36, 2, v36
    s_mov_b32 s27, 524288
    buffer_load_dword v48, v36, s[60:63], s27 offen sc1
    s_mov_b32 s27, 535296
    buffer_load_dword v49, v36, s[60:63], s27 offen sc1
    s_mov_b32 s27, 546304
    buffer_load_dword v50, v36, s[60:63], s27 offen sc1
    s_mov_b32 s27, 557312
    buffer_load_dword v51, v36, s[60:63], s27 offen sc1
    s_mov_b32 s27, 568320
    buffer_load_dword v52, v36, s[60:63], s27 offen sc1
    s_mov_b32 s27, 579328
    buffer_load_dword v53, v36, s[60:63], s27 offen sc1
    s_mov_b32 s27, 590336
    buffer_load_dword v54, v36, s[60:63], s27 offen sc1
    s_mov_b32 s27, 601344
    buffer_load_dword v55, v36, s[60:63], s27 offen sc1
    s_mov_b32 s27, 612352
    buffer_load_dword v56, v36, s[60:63], s27 offen sc1
    s_mov_b32 s27, 623360
    buffer_load_dword v57, v36, s[60:63], s27 offen sc1
    s_mov_b32 s27, 634368
    buffer_load_dword v58, v36, s[60:63], s27 offen sc1
    s_mov_b32 s27, 645376
    buffer_load_dword v59, v36, s[60:63], s27 offen sc1
    s_mov_b32 s27, 656384
    buffer_load_dword v60, v36, s[60:63], s27 offen sc1
    s_mov_b32 s27, 667392
    buffer_load_dword v61, v36, s[60:63], s27 offen sc1
    s_mov_b32 s27, 678400
    buffer_load_dword v62, v36, s[60:63], s27 offen sc1
    s_mov_b32 s27, 689408
    buffer_load_dword v63, v36, s[60:63], s27 offen sc1
    s_lshl_b32 s20, s50, 3
    s_add_u32 s20, s20, s89
    s_and_b32 s21, s7, 7
    s_lshl_b32 s21, s21, 1
    s_and_b32 s22, s89, 1
    s_add_u32 s21, s21, s22
    s_lshr_b32 s23, s89, 1
    s_mul_i32 s38, s23, 22528
    s_lshl_b32 s26, s20, 8
    s_add_u32 s26, s26, 16777216
    s_lshl_b32 s24, s20, 15
    s_add_u32 s24, s24, 14680064
    s_mul_i32 s25, s20, 86
    s_add_u32 s25, s25, s51
    s_lshl_b32 s25, s25, 10
    s_add_u32 s25, s25, 20971520
    s_lshl_b32 s22, s50, 5
    s_add_u32 s22, s22, s53
    s_add_u32 s22, s22, 1152
    v_lshlrev_b32 v6, 3, v240
    v_lshl_add_u32 v6, v241, 15, v6
    v_add_u32 v7, 49152, v3
    v_add_u32 v8, 114688, v3
    s_waitcnt vmcnt(0)
    v_add_f32 v48, v48, v56
    v_add_f32 v49, v49, v57
    v_add_f32 v50, v50, v58
    v_add_f32 v51, v51, v59
    v_add_f32 v52, v52, v60
    v_add_f32 v53, v53, v61
    v_add_f32 v54, v54, v62
    v_add_f32 v55, v55, v63
    v_add_f32 v48, v48, v52
    v_add_f32 v49, v49, v53
    v_add_f32 v50, v50, v54
    v_add_f32 v51, v51, v55
    v_add_f32 v48, v48, v50
    v_add_f32 v49, v49, v51
    v_cvt_pk_bf16_f32 v42, v48, v49
    v_lshlrev_b32 v43, 16, v42
    v_and_b32 v44, 0xffff0000, v42
    v_sub_f32 v43, v48, v43
    v_sub_f32 v44, v49, v44
    v_cvt_pk_bf16_f32 v43, v43, v44
    s_mov_b32 s27, 0x05040100
    s_mov_b32 s28, 0x07060302
    v_perm_b32 v44, v43, v42, s27
    v_mov_b32 v45, v42
    v_perm_b32 v46, v42, v43, s28
    v_mov_b32 v47, 0
    v_cmp_gt_u32 vcc, 32, v2
    s_mul_i32 s26, s89, 0x5556
    s_lshr_b32 s26, s26, 16
    s_mul_i32 s26, s26, 3
    s_sub_u32 s26, s89, s26
    s_lshl_b32 s26, s26, 10
    s_add_u32 s26, s26, 147456
    v_add_u32 v36, s26, v3
    v_cndmask_b32 v44, 0, v44, vcc
    v_cndmask_b32 v45, 0, v45, vcc
    v_cndmask_b32 v46, 0, v46, vcc
    ds_write_b128 v36, v[44:47]
    s_lshl_b32 s26, s20, 8
    s_add_u32 s26, s26, 16777216
    s_cmp_eq_u32 s89, 0
    s_cbranch_scc1 WAIT_22_W0
    buffer_load_dwordx4 v[96:99], v242, s[60:63], s39 offen offset:0 sc1
    buffer_load_dwordx4 v[100:103], v242, s[60:63], s39 offen offset:1024 sc1
    buffer_load_dwordx4 v[104:107], v242, s[60:63], s39 offen offset:2048 sc1
    buffer_load_dwordx4 v[108:111], v242, s[60:63], s39 offen offset:3072 sc1
    s_add_u32 s39, s39, 4096
    buffer_load_dwordx4 v[112:115], v242, s[60:63], s39 offen offset:0 sc1
    buffer_load_dwordx4 v[116:119], v242, s[60:63], s39 offen offset:1024 sc1
    buffer_load_dwordx4 v[120:123], v242, s[60:63], s39 offen offset:2048 sc1
    buffer_load_dwordx4 v[124:127], v242, s[60:63], s39 offen offset:3072 sc1
    s_add_u32 s39, s39, 4096
    s_branch WAIT_22_B
WAIT_22_W0:
    s_cmp_lg_u32 s88, 0
    s_cbranch_scc1 NONCE_23_OK
    s_waitcnt vmcnt(0)
    v_readfirstlane_b32 s88, v249
    s_nop 1
    s_cmp_lg_u32 s88, 0
    s_cbranch_scc1 NONCE_23_OK
    s_mov_b32 s98, 0
NONCE_23_L:
    v_mov_b32 v250, 0
    global_load_dword v251, v250, s[84:85] sc1
    s_waitcnt vmcnt(0)
    v_readfirstlane_b32 s88, v251
    s_add_u32 s98, s98, 1
    s_cmp_gt_u32 s98, 0x4000
    s_cbranch_scc1 NONCE_23_OK
    s_cmp_eq_u32 s88, 0
    s_cbranch_scc1 NONCE_23_L
NONCE_23_OK:
    s_lshl_b32 s98, s50, 5
    s_add_u32 s98, s98, 896
    v_and_b32 v250, 31, v2
    v_add_u32 v250, s98, v250
    v_lshlrev_b32 v250, 7, v250
    s_mov_b32 s98, 0
    buffer_load_dword v251, v250, s[92:95], 0 offen sc1
WAIT_22_L:
    buffer_load_dword v254, v250, s[92:95], 0 offen sc1
    s_waitcnt vmcnt(1)
    v_cmp_ne_u32 vcc, s88, v251
    s_nop 1
    s_cmp_eq_u64 vcc, 0
    s_cbranch_scc1 WAIT_22_E
    buffer_load_dword v251, v250, s[92:95], 0 offen sc1
    s_add_u32 s98, s98, 1
    s_waitcnt vmcnt(1)
    v_cmp_ne_u32 vcc, s88, v254
    s_nop 1
    s_cmp_eq_u64 vcc, 0
    s_cbranch_scc1 WAIT_22_E
    s_cmp_gt_u32 s98, 0x2000
    s_cbranch_scc0 WAIT_22_L
WAIT_22_E:
    buffer_load_dwordx4 v[96:99], v242, s[60:63], s39 offen offset:0 sc1
    buffer_load_dwordx4 v[100:103], v242, s[60:63], s39 offen offset:1024 sc1
    buffer_load_dwordx4 v[104:107], v242, s[60:63], s39 offen offset:2048 sc1
    buffer_load_dwordx4 v[108:111], v242, s[60:63], s39 offen offset:3072 sc1
    s_add_u32 s39, s39, 4096
    buffer_load_dwordx4 v[112:115], v242, s[60:63], s39 offen offset:0 sc1
    buffer_load_dwordx4 v[116:119], v242, s[60:63], s39 offen offset:1024 sc1
    buffer_load_dwordx4 v[120:123], v242, s[60:63], s39 offen offset:2048 sc1
    buffer_load_dwordx4 v[124:127], v242, s[60:63], s39 offen offset:3072 sc1
    s_add_u32 s39, s39, 4096
WAIT_22_B:
    s_waitcnt vmcnt(8) lgkmcnt(0)
    s_barrier
    s_cmp_eq_u32 s52, 0
    s_cbranch_scc1 P5_SKIP
    buffer_load_dwordx2 v[56:57], v6, s[60:63], s26 offen sc1
    s_add_u32 s26, s26, 16384
    buffer_load_dwordx2 v[58:59], v6, s[60:63], s26 offen sc1
    buffer_load_dwordx4 v[152:155], v3, s[60:63], s24 offen offset:0 sc1
    buffer_load_dwordx4 v[156:159], v3, s[60:63], s24 offen offset:1024 sc1
    buffer_load_dwordx4 v[160:163], v3, s[60:63], s24 offen offset:2048 sc1
    buffer_load_dwordx4 v[164:167], v3, s[60:63], s24 offen offset:3072 sc1
    s_add_u32 s24, s24, 4096
    buffer_load_dwordx4 v[168:171], v3, s[60:63], s24 offen offset:0 sc1
    buffer_load_dwordx4 v[172:175], v3, s[60:63], s24 offen offset:1024 sc1
    ds_read_b128 v[16:19], v7 offset:0
    ds_read_b128 v[20:23], v7 offset:1024
    ds_read_b128 v[24:27], v7 offset:2048
    ds_read_b128 v[28:31], v7 offset:3072
    ds_read_b128 v[32:35], v7 offset:4096
    ds_read_b128 v[36:39], v7 offset:5120
    s_cmp_lt_u32 s89, 4
    s_cbranch_scc0 P5_NOPRIO
    s_setprio 1
P5_NOPRIO:
    s_waitcnt vmcnt(5)
    s_waitcnt lgkmcnt(5)
    v_mfma_f32_32x32x16_bf16 v[192:207], v[16:19], v[152:155], 0
    ds_read_b128 v[40:43], v7 offset:6144
    buffer_load_dwordx4 v[176:179], v3, s[60:63], s24 offen offset:2048 sc1
    s_waitcnt lgkmcnt(5)
    v_mfma_f32_32x32x16_bf16 v[208:223], v[20:23], v[152:155], 0
    ds_read_b128 v[44:47], v7 offset:7168
    s_waitcnt lgkmcnt(5)
    v_mfma_f32_32x32x16_bf16 v[224:239], v[24:27], v[152:155], 0
    ds_read_b128 v[48:51], v7 offset:8192
    s_waitcnt vmcnt(5)
    s_waitcnt lgkmcnt(5)
    v_mfma_f32_32x32x16_bf16 v[192:207], v[28:31], v[156:159], v[192:207]
    ds_read_b128 v[16:19], v7 offset:9216
    buffer_load_dwordx4 v[180:183], v3, s[60:63], s24 offen offset:3072 sc1
    s_add_u32 s24, s24, 4096
    s_waitcnt lgkmcnt(5)
    v_mfma_f32_32x32x16_bf16 v[208:223], v[32:35], v[156:159], v[208:223]
    ds_read_b128 v[20:23], v7 offset:10240
    s_waitcnt lgkmcnt(5)
    v_mfma_f32_32x32x16_bf16 v[224:239], v[36:39], v[156:159], v[224:239]
    ds_read_b128 v[24:27], v7 offset:11264
    s_waitcnt vmcnt(5)
    s_waitcnt lgkmcnt(5)
    v_mfma_f32_32x32x16_bf16 v[192:207], v[40:43], v[160:163], v[192:207]
    ds_read_b128 v[28:31], v7 offset:12288
    buffer_load_dwordx4 v[184:187], v3, s[60:63], s24 offen offset:0 sc1
    s_waitcnt lgkmcnt(5)
    v_mfma_f32_32x32x16_bf16 v[208:223], v[44:47], v[160:163], v[208:223]
    ds_read_b128 v[32:35], v7 offset:13312
    s_waitcnt lgkmcnt(5)
    v_mfma_f32_32x32x16_bf16 v[224:239], v[48:51], v[160:163], v[224:239]
    ds_read_b128 v[36:39], v7 offset:14336
    s_waitcnt vmcnt(5)
    s_waitcnt lgkmcnt(5)
    v_mfma_f32_32x32x16_bf16 v[192:207], v[16:19], v[164:167], v[192:207]
    ds_read_b128 v[40:43], v7 offset:15360
    buffer_load_dwordx4 v[188:191], v3, s[60:63], s24 offen offset:1024 sc1
    s_waitcnt lgkmcnt(5)
    v_mfma_f32_32x32x16_bf16 v[208:223], v[20:23], v[164:167], v[208:223]
    ds_read_b128 v[44:47], v7 offset:16384
    s_waitcnt lgkmcnt(5)
    v_mfma_f32_32x32x16_bf16 v[224:239], v[24:27], v[164:167], v[224:239]
    ds_read_b128 v[48:51], v7 offset:17408
    v_add_f32 v56, v56, v58
    v_add_f32 v57, v57, v59
    v_mov_b32 v12, v56
    v_mov_b32 v13, v57
    s_nop 0
    v_permlane32_swap_b32 v56, v12
    v_permlane32_swap_b32 v57, v13
    v_add_f32 v12, v12, v56
    v_add_f32 v13, v13, v57
    v_mul_f32 v12, 0xbb000000, v12
    v_mul_f32 v13, 0x3b000000, v13
    v_fma_f32 v13, -v12, v12, v13
    v_max_f32 v13, 0, v13
    v_add_f32 v13, 0x3727c5ac, v13
    v_rsq_f32 v10, v13
    s_nop 0
    v_mul_f32 v13, v13, v10
    v_cvt_pk_bf16_f32 v11, v12, v13
    v_lshlrev_b32 v14, 16, v11
    v_and_b32 v15, 0xffff0000, v11
    v_sub_f32 v14, v12, v14
    v_sub_f32 v15, v13, v15
    v_cvt_pk_bf16_f32 v12, v14, v15
    s_mov_b32 s36, 0x01000100
    s_mov_b32 s37, 0x07060100
    s_mov_b32 s28, 0x07060302
    v_perm_b32 v52, v11, v11, s36
    v_perm_b32 v53, v11, v12, s37
    v_perm_b32 v54, v12, v11, s28
    v_mov_b32 v55, 0
    v_cmp_gt_u32 vcc, 32, v2
    v_mul_f32 v11, 0xbfb8aa3b, v10
    v_mul_f32 v12, v10, v10
    v_cndmask_b32 v52, 0, v52, vcc
    v_cndmask_b32 v53, 0, v53, vcc
    v_cndmask_b32 v54, 0, v54, vcc
    s_waitcnt vmcnt(5)
    s_waitcnt lgkmcnt(5)
    v_mfma_f32_32x32x16_bf16 v[192:207], v[28:31], v[168:171], v[192:207]
    ds_read_b128 v[16:19], v7 offset:18432
    buffer_load_dwordx4 v[152:155], v3, s[60:63], s24 offen offset:2048 sc1
    s_waitcnt lgkmcnt(5)
    v_mfma_f32_32x32x16_bf16 v[208:223], v[32:35], v[168:171], v[208:223]
    ds_read_b128 v[20:23], v7 offset:19456
    s_waitcnt lgkmcnt(5)
    v_mfma_f32_32x32x16_bf16 v[224:239], v[36:39], v[168:171], v[224:239]
    ds_read_b128 v[24:27], v7 offset:20480
    s_waitcnt vmcnt(5)
    s_waitcnt lgkmcnt(5)
    v_mfma_f32_32x32x16_bf16 v[192:207], v[40:43], v[172:175], v[192:207]
    ds_read_b128 v[28:31], v7 offset:21504
    buffer_load_dwordx4 v[156:159], v3, s[60:63], s24 offen offset:3072 sc1
    s_add_u32 s24, s24, 4096
    s_waitcnt lgkmcnt(5)
    v_mfma_f32_32x32x16_bf16 v[208:223], v[44:47], v[172:175], v[208:223]
    ds_read_b128 v[32:35], v7 offset:22528
    s_waitcnt lgkmcnt(5)
    v_mfma_f32_32x32x16_bf16 v[224:239], v[48:51], v[172:175], v[224:239]
    ds_read_b128 v[36:39], v7 offset:23552
    s_waitcnt vmcnt(5)
    s_waitcnt lgkmcnt(5)
    v_mfma_f32_32x32x16_bf16 v[192:207], v[16:19], v[176:179], v[192:207]
    ds_read_b128 v[40:43], v7 offset:24576
    buffer_load_dwordx4 v[160:163], v3, s[60:63], s24 offen offset:0 sc1
    s_waitcnt lgkmcnt(5)
    v_mfma_f32_32x32x16_bf16 v[208:223], v[20:23], v[176:179], v[208:223]
    ds_read_b128 v[44:47], v7 offset:25600
    s_waitcnt lgkmcnt(5)
    v_mfma_f32_32x32x16_bf16 v[224:239], v[24:27], v[176:179], v[224:239]
    ds_read_b128 v[48:51], v7 offset:26624
    s_waitcnt vmcnt(5)
    s_waitcnt lgkmcnt(5)
    v_mfma_f32_32x32x16_bf16 v[192:207], v[28:31], v[180:183], v[192:207]
    ds_read_b128 v[16:19], v7 offset:27648
    buffer_load_dwordx4 v[164:167], v3, s[60:63], s24 offen offset:1024 sc1
    s_waitcnt lgkmcnt(5)
    v_mfma_f32_32x32x16_bf16 v[208:223], v[32:35], v[180:183], v[208:223]
    ds_read_b128 v[20:23], v7 offset:28672
    s_waitcnt lgkmcnt(5)
    v_mfma_f32_32x32x16_bf16 v[224:239], v[36:39], v[180:183], v[224:239]
    ds_read_b128 v[24:27], v7 offset:29696
    s_waitcnt vmcnt(5)
    s_waitcnt lgkmcnt(5)
    v_mfma_f32_32x32x16_bf16 v[192:207], v[40:43], v[184:187], v[192:207]
    ds_read_b128 v[28:31], v7 offset:30720
    buffer_load_dwordx4 v[168:171], v3, s[60:63], s24 offen offset:2048 sc1
    s_waitcnt lgkmcnt(5)
    v_mfma_f32_32x32x16_bf16 v[208:223], v[44:47], v[184:187], v[208:223]
    ds_read_b128 v[32:35], v7 offset:31744
    s_waitcnt lgkmcnt(5)
    v_mfma_f32_32x32x16_bf16 v[224:239], v[48:51], v[184:187], v[224:239]
    ds_read_b128 v[36:39], v7 offset:32768
    s_waitcnt vmcnt(5)
    s_waitcnt lgkmcnt(5)
    v_mfma_f32_32x32x16_bf16 v[192:207], v[16:19], v[188:191], v[192:207]
    ds_read_b128 v[40:43], v7 offset:33792
    buffer_load_dwordx4 v[172:175], v3, s[60:63], s24 offen offset:3072 sc1
    s_add_u32 s24, s24, 4096
    s_waitcnt lgkmcnt(5)
    v_mfma_f32_32x32x16_bf16 v[208:223], v[20:23], v[188:191], v[208:223]
    ds_read_b128 v[44:47], v7 offset:34816
    s_waitcnt lgkmcnt(5)
    v_mfma_f32_32x32x16_bf16 v[224:239], v[24:27], v[188:191], v[224:239]
    ds_read_b128 v[48:51], v7 offset:35840
    s_waitcnt vmcnt(5)
    s_waitcnt lgkmcnt(5)
    v_mfma_f32_32x32x16_bf16 v[192:207], v[28:31], v[152:155], v[192:207]
    ds_read_b128 v[16:19], v7 offset:36864
    buffer_load_dwordx4 v[176:179], v3, s[60:63], s24 offen offset:0 sc1
    s_waitcnt lgkmcnt(5)
    v_mfma_f32_32x32x16_bf16 v[208:223], v[32:35], v[152:155], v[208:223]
    ds_read_b128 v[20:23], v7 offset:37888
    s_waitcnt lgkmcnt(5)
    v_mfma_f32_32x32x16_bf16 v[224:239], v[36:39], v[152:155], v[224:239]
    ds_read_b128 v[24:27], v7 offset:38912
    s_waitcnt vmcnt(5)
    s_waitcnt lgkmcnt(5)
    v_mfma_f32_32x32x16_bf16 v[192:207], v[40:43], v[156:159], v[192:207]
    ds_read_b128 v[28:31], v7 offset:39936
    buffer_load_dwordx4 v[180:183], v3, s[60:63], s24 offen offset:1024 sc1
    s_waitcnt lgkmcnt(5)
    v_mfma_f32_32x32x16_bf16 v[208:223], v[44:47], v[156:159], v[208:223]
    ds_read_b128 v[32:35], v7 offset:40960
    s_waitcnt lgkmcnt(5)
    v_mfma_f32_32x32x16_bf16 v[224:239], v[48:51], v[156:159], v[224:239]
    ds_read_b128 v[36:39], v7 offset:41984
    s_waitcnt vmcnt(5)
    s_waitcnt lgkmcnt(5)
    v_mfma_f32_32x32x16_bf16 v[192:207], v[16:19], v[160:163], v[192:207]
    ds_read_b128 v[40:43], v7 offset:43008
    buffer_load_dwordx4 v[184:187], v3, s[60:63], s24 offen offset:2048 sc1
    s_waitcnt lgkmcnt(5)
    v_mfma_f32_32x32x16_bf16 v[208:223], v[20:23], v[160:163], v[208:223]
    ds_read_b128 v[44:47], v7 offset:44032
    s_waitcnt lgkmcnt(5)
    v_mfma_f32_32x32x16_bf16 v[224:239], v[24:27], v[160:163], v[224:239]
    ds_read_b128 v[48:51], v7 offset:45056
    s_waitcnt vmcnt(5)
    s_waitcnt lgkmcnt(5)
    v_mfma_f32_32x32x16_bf16 v[192:207], v[28:31], v[164:167], v[192:207]
    ds_read_b128 v[16:19], v7 offset:46080
    buffer_load_dwordx4 v[188:191], v3, s[60:63], s24 offen offset:3072 sc1
    s_add_u32 s24, s24, 4096
    s_waitcnt lgkmcnt(5)
    v_mfma_f32_32x32x16_bf16 v[208:223], v[32:35], v[164:167], v[208:223]
    ds_read_b128 v[20:23], v7 offset:47104
    s_waitcnt lgkmcnt(5)
    v_mfma_f32_32x32x16_bf16 v[224:239], v[36:39], v[164:167], v[224:239]
    ds_read_b128 v[24:27], v7 offset:48128
    s_waitcnt vmcnt(5)
    s_waitcnt lgkmcnt(5)
    v_mfma_f32_32x32x16_bf16 v[192:207], v[40:43], v[168:171], v[192:207]
    ds_read_b128 v[28:31], v7 offset:49152
    buffer_load_dwordx4 v[152:155], v3, s[60:63], s24 offen offset:0 sc1
    s_waitcnt lgkmcnt(5)
    v_mfma_f32_32x32x16_bf16 v[208:223], v[44:47], v[168:171], v[208:223]
    ds_read_b128 v[32:35], v7 offset:50176
    s_waitcnt lgkmcnt(5)
    v_mfma_f32_32x32x16_bf16 v[224:239], v[48:51], v[168:171], v[224:239]
    ds_read_b128 v[36:39], v7 offset:51200
    s_waitcnt vmcnt(5)
    s_waitcnt lgkmcnt(5)
    v_mfma_f32_32x32x16_bf16 v[192:207], v[16:19], v[172:175], v[192:207]
    ds_read_b128 v[40:43], v7 offset:52224
    buffer_load_dwordx4 v[156:159], v3, s[60:63], s24 offen offset:1024 sc1
    s_waitcnt lgkmcnt(5)
    v_mfma_f32_32x32x16_bf16 v[208:223], v[20:23], v[172:175], v[208:223]
    ds_read_b128 v[44:47], v7 offset:53248
    s_waitcnt lgkmcnt(5)
    v_mfma_f32_32x32x16_bf16 v[224:239], v[24:27], v[172:175], v[224:239]
    ds_read_b128 v[48:51], v7 offset:54272
    s_waitcnt vmcnt(5)
    s_waitcnt lgkmcnt(5)
    v_mfma_f32_32x32x16_bf16 v[192:207], v[28:31], v[176:179], v[192:207]
    ds_read_b128 v[16:19], v7 offset:55296
    buffer_load_dwordx4 v[160:163], v3, s[60:63], s24 offen offset:2048 sc1
    s_waitcnt lgkmcnt(5)
    v_mfma_f32_32x32x16_bf16 v[208:223], v[32:35], v[176:179], v[208:223]
    ds_read_b128 v[20:23], v7 offset:56320
    s_waitcnt lgkmcnt(5)
    v_mfma_f32_32x32x16_bf16 v[224:239], v[36:39], v[176:179], v[224:239]
    ds_read_b128 v[24:27], v7 offset:57344
    s_waitcnt vmcnt(5)
    s_waitcnt lgkmcnt(5)
    v_mfma_f32_32x32x16_bf16 v[192:207], v[40:43], v[180:183], v[192:207]
    ds_read_b128 v[28:31], v7 offset:58368
    buffer_load_dwordx4 v[164:167], v3, s[60:63], s24 offen offset:3072 sc1
    s_add_u32 s24, s24, 4096
    s_waitcnt lgkmcnt(5)
    v_mfma_f32_32x32x16_bf16 v[208:223], v[44:47], v[180:183], v[208:223]
    ds_read_b128 v[32:35], v7 offset:59392
    s_waitcnt lgkmcnt(5)
    v_mfma_f32_32x32x16_bf16 v[224:239], v[48:51], v[180:183], v[224:239]
    ds_read_b128 v[36:39], v7 offset:60416
    s_waitcnt vmcnt(5)
    s_waitcnt lgkmcnt(5)
    v_mfma_f32_32x32x16_bf16 v[192:207], v[16:19], v[184:187], v[192:207]
    ds_read_b128 v[40:43], v7 offset:61440
    buffer_load_dwordx4 v[168:171], v3, s[60:63], s24 offen offset:0 sc1
    s_waitcnt lgkmcnt(5)
    v_mfma_f32_32x32x16_bf16 v[208:223], v[20:23], v[184:187], v[208:223]
    ds_read_b128 v[44:47], v7 offset:62464
    s_waitcnt lgkmcnt(5)
    v_mfma_f32_32x32x16_bf16 v[224:239], v[24:27], v[184:187], v[224:239]
    ds_read_b128 v[48:51], v7 offset:63488
    s_waitcnt vmcnt(5)
    s_waitcnt lgkmcnt(5)
    v_mfma_f32_32x32x16_bf16 v[192:207], v[28:31], v[188:191], v[192:207]
    ds_read_b128 v[16:19], v7 offset:64512
    buffer_load_dwordx4 v[172:175], v3, s[60:63], s24 offen offset:1024 sc1
    s_waitcnt lgkmcnt(5)
    v_mfma_f32_32x32x16_bf16 v[208:223], v[32:35], v[188:191], v[208:223]
    ds_read_b128 v[20:23], v8 offset:0
    s_waitcnt lgkmcnt(5)
    v_mfma_f32_32x32x16_bf16 v[224:239], v[36:39], v[188:191], v[224:239]
    ds_read_b128 v[24:27], v8 offset:1024
    s_waitcnt vmcnt(5)
    s_waitcnt lgkmcnt(5)
    v_mfma_f32_32x32x16_bf16 v[192:207], v[40:43], v[152:155], v[192:207]
    ds_read_b128 v[28:31], v8 offset:2048
    buffer_load_dwordx4 v[176:179], v3, s[60:63], s24 offen offset:2048 sc1
    s_waitcnt lgkmcnt(5)
    v_mfma_f32_32x32x16_bf16 v[208:223], v[44:47], v[152:155], v[208:223]
    ds_read_b128 v[32:35], v8 offset:3072
    s_waitcnt lgkmcnt(5)
    v_mfma_f32_32x32x16_bf16 v[224:239], v[48:51], v[152:155], v[224:239]
    ds_read_b128 v[36:39], v8 offset:4096
    s_waitcnt vmcnt(5)
    s_waitcnt lgkmcnt(5)
    v_mfma_f32_32x32x16_bf16 v[192:207], v[16:19], v[156:159], v[192:207]
    ds_read_b128 v[40:43], v8 offset:5120
    buffer_load_dwordx4 v[180:183], v3, s[60:63], s24 offen offset:3072 sc1
    s_add_u32 s24, s24, 4096
    s_waitcnt lgkmcnt(5)
    v_mfma_f32_32x32x16_bf16 v[208:223], v[20:23], v[156:159], v[208:223]
    ds_read_b128 v[44:47], v8 offset:6144
    s_waitcnt lgkmcnt(5)
    v_mfma_f32_32x32x16_bf16 v[224:239], v[24:27], v[156:159], v[224:239]
    ds_read_b128 v[48:51], v8 offset:7168
    s_waitcnt vmcnt(5)
    s_waitcnt lgkmcnt(5)
    v_mfma_f32_32x32x16_bf16 v[192:207], v[28:31], v[160:163], v[192:207]
    ds_read_b128 v[16:19], v8 offset:8192
    buffer_load_dwordx4 v[184:187], v3, s[60:63], s24 offen offset:0 sc1
    s_waitcnt lgkmcnt(5)
    v_mfma_f32_32x32x16_bf16 v[208:223], v[32:35], v[160:163], v[208:223]
    ds_read_b128 v[20:23], v8 offset:9216
    s_waitcnt lgkmcnt(5)
    v_mfma_f32_32x32x16_bf16 v[224:239], v[36:39], v[160:163], v[224:239]
    ds_read_b128 v[24:27], v8 offset:10240
    s_waitcnt vmcnt(5)
    s_waitcnt lgkmcnt(5)
    v_mfma_f32_32x32x16_bf16 v[192:207], v[40:43], v[164:167], v[192:207]
    ds_read_b128 v[28:31], v8 offset:11264
    buffer_load_dwordx4 v[188:191], v3, s[60:63], s24 offen offset:1024 sc1
    s_waitcnt lgkmcnt(5)
    v_mfma_f32_32x32x16_bf16 v[208:223], v[44:47], v[164:167], v[208:223]
    ds_read_b128 v[32:35], v8 offset:12288
    s_waitcnt lgkmcnt(5)
    v_mfma_f32_32x32x16_bf16 v[224:239], v[48:51], v[164:167], v[224:239]
    ds_read_b128 v[36:39], v8 offset:13312
    s_waitcnt vmcnt(5)
    s_waitcnt lgkmcnt(5)
    v_mfma_f32_32x32x16_bf16 v[192:207], v[16:19], v[168:171], v[192:207]
    ds_read_b128 v[40:43], v8 offset:14336
    buffer_load_dwordx4 v[152:155], v3, s[60:63], s24 offen offset:2048 sc1
    s_waitcnt lgkmcnt(5)
    v_mfma_f32_32x32x16_bf16 v[208:223], v[20:23], v[168:171], v[208:223]
    ds_read_b128 v[44:47], v8 offset:15360
    s_waitcnt lgkmcnt(5)
    v_mfma_f32_32x32x16_bf16 v[224:239], v[24:27], v[168:171], v[224:239]
    ds_read_b128 v[48:51], v8 offset:16384
    s_waitcnt vmcnt(5)
    s_waitcnt lgkmcnt(5)
    v_mfma_f32_32x32x16_bf16 v[192:207], v[28:31], v[172:175], v[192:207]
    ds_read_b128 v[16:19], v8 offset:17408
    buffer_load_dwordx4 v[156:159], v3, s[60:63], s24 offen offset:3072 sc1
    s_add_u32 s24, s24, 4096
    s_waitcnt lgkmcnt(5)
    v_mfma_f32_32x32x16_bf16 v[208:223], v[32:35], v[172:175], v[208:223]
    ds_read_b128 v[20:23], v8 offset:18432
    s_waitcnt lgkmcnt(5)
    v_mfma_f32_32x32x16_bf16 v[224:239], v[36:39], v[172:175], v[224:239]
    ds_read_b128 v[24:27], v8 offset:19456
    s_waitcnt vmcnt(5)
    s_waitcnt lgkmcnt(5)
    v_mfma_f32_32x32x16_bf16 v[192:207], v[40:43], v[176:179], v[192:207]
    ds_read_b128 v[28:31], v8 offset:20480
    s_waitcnt lgkmcnt(5)
    v_mfma_f32_32x32x16_bf16 v[208:223], v[44:47], v[176:179], v[208:223]
    ds_read_b128 v[32:35], v8 offset:21504
    s_waitcnt lgkmcnt(5)
    v_mfma_f32_32x32x16_bf16 v[224:239], v[48:51], v[176:179], v[224:239]
    ds_read_b128 v[36:39], v8 offset:22528
    s_waitcnt vmcnt(4)
    s_waitcnt lgkmcnt(5)
    v_mfma_f32_32x32x16_bf16 v[192:207], v[16:19], v[180:183], v[192:207]
    ds_read_b128 v[40:43], v8 offset:23552
    s_waitcnt lgkmcnt(5)
    v_mfma_f32_32x32x16_bf16 v[208:223], v[20:23], v[180:183], v[208:223]
    ds_read_b128 v[44:47], v8 offset:24576
    s_waitcnt lgkmcnt(5)
    v_mfma_f32_32x32x16_bf16 v[224:239], v[24:27], v[180:183], v[224:239]
    ds_read_b128 v[48:51], v8 offset:25600
    s_waitcnt vmcnt(3)
    s_waitcnt lgkmcnt(5)
    v_mfma_f32_32x32x16_bf16 v[192:207], v[28:31], v[184:187], v[192:207]
    ds_read_b128 v[16:19], v8 offset:26624
    s_waitcnt lgkmcnt(5)
    v_mfma_f32_32x32x16_bf16 v[208:223], v[32:35], v[184:187], v[208:223]
    ds_read_b128 v[20:23], v8 offset:27648
    s_waitcnt lgkmcnt(5)
    v_mfma_f32_32x32x16_bf16 v[224:239], v[36:39], v[184:187], v[224:239]
    ds_read_b128 v[24:27], v8 offset:28672
    s_waitcnt vmcnt(2)
    s_waitcnt lgkmcnt(5)
    v_mfma_f32_32x32x16_bf16 v[192:207], v[40:43], v[188:191], v[192:207]
    ds_read_b128 v[28:31], v8 offset:29696
    s_waitcnt lgkmcnt(5)
    v_mfma_f32_32x32x16_bf16 v[208:223], v[44:47], v[188:191], v[208:223]
    ds_read_b128 v[32:35], v8 offset:30720
    s_waitcnt lgkmcnt(5)
    v_mfma_f32_32x32x16_bf16 v[224:239], v[48:51], v[188:191], v[224:239]
    ds_read_b128 v[36:39], v8 offset:31744
    s_waitcnt vmcnt(1)
    s_waitcnt lgkmcnt(5)
    v_mfma_f32_32x32x16_bf16 v[192:207], v[16:19], v[152:155], v[192:207]
    ds_read_b128 v[40:43], v8 offset:32768
    s_waitcnt lgkmcnt(5)
    v_mfma_f32_32x32x16_bf16 v[208:223], v[20:23], v[152:155], v[208:223]
    ds_read_b128 v[44:47], v8 offset:33792
    s_waitcnt lgkmcnt(5)
    v_mfma_f32_32x32x16_bf16 v[224:239], v[24:27], v[152:155], v[224:239]
    ds_read_b128 v[48:51], v8 offset:34816
    s_waitcnt vmcnt(0)
    s_waitcnt lgkmcnt(5)
    v_mfma_f32_32x32x16_bf16 v[192:207], v[28:31], v[156:159], v[192:207]
    s_waitcnt lgkmcnt(4)
    v_mfma_f32_32x32x16_bf16 v[208:223], v[32:35], v[156:159], v[208:223]
    s_waitcnt lgkmcnt(3)
    v_mfma_f32_32x32x16_bf16 v[224:239], v[36:39], v[156:159], v[224:239]
    s_waitcnt lgkmcnt(2)
    v_mfma_f32_32x32x16_bf16 v[192:207], v[40:43], v[52:55], v[192:207]
    s_waitcnt lgkmcnt(1)
    v_mfma_f32_32x32x16_bf16 v[208:223], v[44:47], v[52:55], v[208:223]
    s_waitcnt lgkmcnt(0)
    v_mfma_f32_32x32x16_bf16 v[224:239], v[48:51], v[52:55], v[224:239]
    v_mov_b32 v14, v11
    v_mov_b32 v15, v11
    v_mov_b32 v13, v12
    v_mov_b32 v36, 1.0
    v_mov_b32 v37, 1.0
    s_nop 2
    v_pk_mul_f32 v[16:17], v[192:193], v[14:15]
    v_pk_mul_f32 v[18:19], v[194:195], v[14:15]
    v_pk_mul_f32 v[20:21], v[196:197], v[14:15]
    v_pk_mul_f32 v[22:23], v[198:199], v[14:15]
    v_exp_f32 v16, v16
    v_exp_f32 v17, v17
    v_exp_f32 v18, v18
    v_exp_f32 v19, v19
    v_exp_f32 v20, v20
    v_exp_f32 v21, v21
    v_exp_f32 v22, v22
    v_exp_f32 v23, v23
    v_pk_mul_f32 v[192:193], v[192:193], v[200:201]
    v_pk_mul_f32 v[194:195], v[194:195], v[202:203]
    v_pk_mul_f32 v[196:197], v[196:197], v[204:205]
    v_pk_mul_f32 v[198:199], v[198:199], v[206:207]
    v_pk_add_f32 v[16:17], v[16:17], v[36:37]
    v_pk_add_f32 v[18:19], v[18:19], v[36:37]
    v_pk_add_f32 v[20:21], v[20:21], v[36:37]
    v_pk_add_f32 v[22:23], v[22:23], v[36:37]
    v_pk_mul_f32 v[192:193], v[192:193], v[12:13]
    v_pk_mul_f32 v[194:195], v[194:195], v[12:13]
    v_pk_mul_f32 v[196:197], v[196:197], v[12:13]
    v_pk_mul_f32 v[198:199], v[198:199], v[12:13]
    v_rcp_f32 v16, v16
    v_rcp_f32 v17, v17
    v_rcp_f32 v18, v18
    v_rcp_f32 v19, v19
    v_rcp_f32 v20, v20
    v_rcp_f32 v21, v21
    v_rcp_f32 v22, v22
    v_rcp_f32 v23, v23
    v_pk_mul_f32 v[192:193], v[192:193], v[16:17]
    v_pk_mul_f32 v[194:195], v[194:195], v[18:19]
    v_pk_mul_f32 v[196:197], v[196:197], v[20:21]
    v_pk_mul_f32 v[198:199], v[198:199], v[22:23]
    v_cvt_pk_bf16_f32 v24, v192, v193
    v_cvt_pk_bf16_f32 v25, v194, v195
    v_cvt_pk_bf16_f32 v26, v196, v197
    v_cvt_pk_bf16_f32 v27, v198, v199
    buffer_store_dwordx4 v[24:27], v3, s[60:63], s25 offen offset:0 sc1
    v_pk_mul_f32 v[16:17], v[208:209], v[14:15]
    v_pk_mul_f32 v[18:19], v[210:211], v[14:15]
    v_pk_mul_f32 v[20:21], v[212:213], v[14:15]
    v_pk_mul_f32 v[22:23], v[214:215], v[14:15]
    v_exp_f32 v16, v16
    v_exp_f32 v17, v17
    v_exp_f32 v18, v18
    v_exp_f32 v19, v19
    v_exp_f32 v20, v20
    v_exp_f32 v21, v21
    v_exp_f32 v22, v22
    v_exp_f32 v23, v23
    v_pk_mul_f32 v[208:209], v[208:209], v[216:217]
    v_pk_mul_f32 v[210:211], v[210:211], v[218:219]
    v_pk_mul_f32 v[212:213], v[212:213], v[220:221]
    v_pk_mul_f32 v[214:215], v[214:215], v[222:223]
    v_pk_add_f32 v[16:17], v[16:17], v[36:37]
    v_pk_add_f32 v[18:19], v[18:19], v[36:37]
    v_pk_add_f32 v[20:21], v[20:21], v[36:37]
    v_pk_add_f32 v[22:23], v[22:23], v[36:37]
    v_pk_mul_f32 v[208:209], v[208:209], v[12:13]
    v_pk_mul_f32 v[210:211], v[210:211], v[12:13]
    v_pk_mul_f32 v[212:213], v[212:213], v[12:13]
    v_pk_mul_f32 v[214:215], v[214:215], v[12:13]
    v_rcp_f32 v16, v16
    v_rcp_f32 v17, v17
    v_rcp_f32 v18, v18
    v_rcp_f32 v19, v19
    v_rcp_f32 v20, v20
    v_rcp_f32 v21, v21
    v_rcp_f32 v22, v22
    v_rcp_f32 v23, v23
    v_pk_mul_f32 v[208:209], v[208:209], v[16:17]
    v_pk_mul_f32 v[210:211], v[210:211], v[18:19]
    v_pk_mul_f32 v[212:213], v[212:213], v[20:21]
    v_pk_mul_f32 v[214:215], v[214:215], v[22:23]
    v_cvt_pk_bf16_f32 v28, v208, v209
    v_cvt_pk_bf16_f32 v29, v210, v211
    v_cvt_pk_bf16_f32 v30, v212, v213
    v_cvt_pk_bf16_f32 v31, v214, v215
    buffer_store_dwordx4 v[28:31], v3, s[60:63], s25 offen offset:1024 sc1
    v_pk_mul_f32 v[16:17], v[224:225], v[14:15]
    v_pk_mul_f32 v[18:19], v[226:227], v[14:15]
    v_pk_mul_f32 v[20:21], v[228:229], v[14:15]
    v_pk_mul_f32 v[22:23], v[230:231], v[14:15]
    v_exp_f32 v16, v16
    v_exp_f32 v17, v17
    v_exp_f32 v18, v18
    v_exp_f32 v19, v19
    v_exp_f32 v20, v20
    v_exp_f32 v21, v21
    v_exp_f32 v22, v22
    v_exp_f32 v23, v23
    v_pk_mul_f32 v[224:225], v[224:225], v[232:233]
    v_pk_mul_f32 v[226:227], v[226:227], v[234:235]
    v_pk_mul_f32 v[228:229], v[228:229], v[236:237]
    v_pk_mul_f32 v[230:231], v[230:231], v[238:239]
    v_pk_add_f32 v[16:17], v[16:17], v[36:37]
    v_pk_add_f32 v[18:19], v[18:19], v[36:37]
    v_pk_add_f32 v[20:21], v[20:21], v[36:37]
    v_pk_add_f32 v[22:23], v[22:23], v[36:37]
    v_pk_mul_f32 v[224:225], v[224:225], v[12:13]
    v_pk_mul_f32 v[226:227], v[226:227], v[12:13]
    v_pk_mul_f32 v[228:229], v[228:229], v[12:13]
    v_pk_mul_f32 v[230:231], v[230:231], v[12:13]
    v_rcp_f32 v16, v16
    v_rcp_f32 v17, v17
    v_rcp_f32 v18, v18
    v_rcp_f32 v19, v19
    v_rcp_f32 v20, v20
    v_rcp_f32 v21, v21
    v_rcp_f32 v22, v22
    v_rcp_f32 v23, v23
    v_pk_mul_f32 v[224:225], v[224:225], v[16:17]
    v_pk_mul_f32 v[226:227], v[226:227], v[18:19]
    v_pk_mul_f32 v[228:229], v[228:229], v[20:21]
    v_pk_mul_f32 v[230:231], v[230:231], v[22:23]
    v_cvt_pk_bf16_f32 v32, v224, v225
    v_cvt_pk_bf16_f32 v33, v226, v227
    v_cvt_pk_bf16_f32 v34, v228, v229
    v_cvt_pk_bf16_f32 v35, v230, v231
    buffer_store_dwordx4 v[32:35], v3, s[60:63], s25 offen offset:2048 sc1
    s_setprio 0
    s_waitcnt vmcnt(0) lgkmcnt(0)
    s_barrier
    s_cmp_eq_u32 s89, 0
    s_cbranch_scc0 PUB_24
    s_cmp_lg_u32 s88, 0
    s_cbranch_scc1 NONCE_25_OK
    s_waitcnt vmcnt(0)
    v_readfirstlane_b32 s88, v249
    s_nop 1
    s_cmp_lg_u32 s88, 0
    s_cbranch_scc1 NONCE_25_OK
    s_mov_b32 s98, 0
NONCE_25_L:
    v_mov_b32 v250, 0
    global_load_dword v251, v250, s[84:85] sc1
    s_waitcnt vmcnt(0)
    v_readfirstlane_b32 s88, v251
    s_add_u32 s98, s98, 1
    s_cmp_gt_u32 s98, 0x4000
    s_cbranch_scc1 NONCE_25_OK
    s_cmp_eq_u32 s88, 0
    s_cbranch_scc1 NONCE_25_L
NONCE_25_OK:
    s_lshl_b32 s98, s22, 7
    v_mov_b32 v250, s98
    v_mov_b32 v251, s88
    s_mov_b64 exec, 1
    buffer_store_dword v251, v250, s[92:95], 0 offen sc1
    s_mov_b64 exec, -1
PUB_24:
P5_SKIP:
    s_lshl_b32 s20, s6, 2
    s_lshr_b32 s22, s7, 3
    s_add_u32 s20, s20, s22
    s_and_b32 s22, s89, 1
    s_lshr_b32 s25, s23, 1
    s_and_b32 s26, s23, 1
    s_lshl_b32 s27, s20, 1
    s_add_u32 s54, s27, s25
    s_xor_b32 s55, s25, 1
    s_add_u32 s55, s27, s55
    s_mov_b32 s8, s82
    s_mov_b32 s9, s83
    s_mov_b32 s10, 0x200000
    s_mov_b32 s11, 0x20000
    v_lshlrev_b32 v8, 4, v241
    s_lshl_b32 s57, s21, 7
    s_lshl_b32 s59, s26, 6
    s_add_u32 s57, s57, s59
    s_add_u32 s57, s57, 51200
    buffer_load_dwordx4 v[168:171], v8, s[60:63], s57 offen sc1
    buffer_load_dwordx4 v[172:175], v8, s[60:63], s57 offen offset:32 sc1
    s_add_u32 s57, s27, s22
    s_mul_i32 s57, s57, 88064
    s_add_u32 s57, s57, s38
    s_add_u32 s57, s57, 20971520
    s_mul_i32 s59, s23, 40960
    s_mul_i32 s48, s22, 20480
    s_add_u32 s59, s59, s48
    s_mul_i32 s44, s54, 88064
    s_add_u32 s44, s44, s38
    s_add_u32 s44, s44, 20992000
    s_add_u32 s44, s44, s33
    s_mul_i32 s45, s55, 88064
    s_add_u32 s45, s45, s38
    s_add_u32 s45, s45, 20992000
    s_add_u32 s45, s45, s33
    s_lshl_b32 s46, s54, 15
    s_lshl_b32 s47, s21, 11
    s_add_u32 s46, s46, s47
    s_lshl_b32 s47, s26, 10
    s_add_u32 s46, s46, s47
    s_add_u32 s46, s46, 14680064
    s_mul_i32 s47, s23, 40960
    s_mul_i32 s48, s25, 20480
    s_add_u32 s48, s48, s47
    v_add_u32 v9, s48, v3
    s_xor_b32 s48, s25, 1
    s_mul_i32 s48, s48, 20480
    s_add_u32 s48, s48, s47
    v_add_u32 v10, s48, v3
    s_xor_b32 s48, s23, 1
    s_lshl_b32 s48, s48, 1
    s_add_u32 s48, s48, s22
    s_mul_i32 s48, s48, 6144
    s_add_u32 s48, s48, 0
    v_add_u32 v11, s48, v3
    s_xor_b32 s48, s23, 2
    s_lshl_b32 s48, s48, 1
    s_add_u32 s48, s48, s22
    s_mul_i32 s48, s48, 6144
    s_add_u32 s48, s48, 2048
    v_add_u32 v12, s48, v3
    s_xor_b32 s48, s23, 3
    s_lshl_b32 s48, s48, 1
    s_add_u32 s48, s48, s22
    s_mul_i32 s48, s48, 6144
    s_add_u32 s48, s48, 4096
    v_add_u32 v13, s48, v3
    s_mul_i32 s48, s89, 6144
    v_add_u32 v14, s48, v3
    v_lshlrev_b32 v7, 10, v240
    v_lshl_add_u32 v7, v241, 4, v7
    s_lshl_b32 s49, s54, 15
    s_lshl_b32 s48, s21, 6
    s_add_u32 s49, s49, s48
    s_lshl_b32 s48, s26, 5
    s_add_u32 s49, s49, s48
    s_cmp_eq_u32 s89, 0
    s_cbranch_scc1 WAIT_26_W0
    buffer_load_dwordx4 v[128:131], v242, s[60:63], s39 offen offset:0 sc1
    buffer_load_dwordx4 v[132:135], v242, s[60:63], s39 offen offset:1024 sc1
    buffer_load_dwordx4 v[136:139], v242, s[60:63], s39 offen offset:2048 sc1
    buffer_load_dwordx4 v[140:143], v242, s[60:63], s39 offen offset:3072 sc1
    s_add_u32 s39, s39, 4096
    s_add_u32 s39, s39, s33
    buffer_load_dwordx4 v[144:147], v242, s[60:63], s39 offen offset:0 sc1
    buffer_load_dwordx4 v[148:151], v242, s[60:63], s39 offen offset:1024 sc1
    s_branch WAIT_26_B
WAIT_26_W0:
    s_cmp_lg_u32 s88, 0
    s_cbranch_scc1 NONCE_27_OK
    s_waitcnt vmcnt(0)
    v_readfirstlane_b32 s88, v249
    s_nop 1
    s_cmp_lg_u32 s88, 0
    s_cbranch_scc1 NONCE_27_OK
    s_mov_b32 s98, 0
NONCE_27_L:
    v_mov_b32 v250, 0
    global_load_dword v251, v250, s[84:85] sc1
    s_waitcnt vmcnt(0)
    v_readfirstlane_b32 s88, v251
    s_add_u32 s98, s98, 1
    s_cmp_gt_u32 s98, 0x4000
    s_cbranch_scc1 NONCE_27_OK
    s_cmp_eq_u32 s88, 0
    s_cbranch_scc1 NONCE_27_L
NONCE_27_OK:
    s_lshr_b32 s98, s20, 2
    s_lshl_b32 s98, s98, 5
    s_add_u32 s98, s98, 1152
    v_min_u32 v250, 28, v2
    v_add_u32 v250, s98, v250
    v_lshlrev_b32 v250, 7, v250
    s_mov_b32 s98, 0
    buffer_load_dword v251, v250, s[92:95], 0 offen sc1
WAIT_26_L:
    buffer_load_dword v254, v250, s[92:95], 0 offen sc1
    s_waitcnt vmcnt(1)
    v_cmp_ne_u32 vcc, s88, v251
    s_nop 1
    s_cmp_eq_u64 vcc, 0
    s_cbranch_scc1 WAIT_26_E
    buffer_load_dword v251, v250, s[92:95], 0 offen sc1
    s_add_u32 s98, s98, 1
    s_waitcnt vmcnt(1)
    v_cmp_ne_u32 vcc, s88, v254
    s_nop 1
    s_cmp_eq_u64 vcc, 0
    s_cbranch_scc1 WAIT_26_E
    s_cmp_gt_u32 s98, 0x2000
    s_cbranch_scc0 WAIT_26_L
WAIT_26_E:
    buffer_load_dwordx4 v[128:131], v242, s[60:63], s39 offen offset:0 sc1
    buffer_load_dwordx4 v[132:135], v242, s[60:63], s39 offen offset:1024 sc1
    buffer_load_dwordx4 v[136:139], v242, s[60:63], s39 offen offset:2048 sc1
    buffer_load_dwordx4 v[140:143], v242, s[60:63], s39 offen offset:3072 sc1
    s_add_u32 s39, s39, 4096
    s_add_u32 s39, s39, s33
    buffer_load_dwordx4 v[144:147], v242, s[60:63], s39 offen offset:0 sc1
    buffer_load_dwordx4 v[148:151], v242, s[60:63], s39 offen offset:1024 sc1
WAIT_26_B:
    s_barrier
    s_add_u32 m0, s59, 0
    s_add_u32 s48, s57, 0
    buffer_load_dwordx4 v3, s[60:63], s48 offen offset:0 sc1 lds
    buffer_load_dwordx4 v3, s[60:63], s48 offen offset:1024 sc1 lds
    buffer_load_dwordx4 v3, s[60:63], s48 offen offset:2048 sc1 lds
    buffer_load_dwordx4 v3, s[60:63], s48 offen offset:3072 sc1 lds
    s_add_u32 m0, s59, 4096
    s_add_u32 s48, s57, 4096
    buffer_load_dwordx4 v3, s[60:63], s48 offen offset:0 sc1 lds
    buffer_load_dwordx4 v3, s[60:63], s48 offen offset:1024 sc1 lds
    buffer_load_dwordx4 v3, s[60:63], s48 offen offset:2048 sc1 lds
    buffer_load_dwordx4 v3, s[60:63], s48 offen offset:3072 sc1 lds
    s_add_u32 m0, s59, 8192
    s_add_u32 s48, s57, 8192
    buffer_load_dwordx4 v3, s[60:63], s48 offen offset:0 sc1 lds
    buffer_load_dwordx4 v3, s[60:63], s48 offen offset:1024 sc1 lds
    buffer_load_dwordx4 v3, s[60:63], s48 offen offset:2048 sc1 lds
    buffer_load_dwordx4 v3, s[60:63], s48 offen offset:3072 sc1 lds
    s_waitcnt vmcnt(8)
    s_barrier
    s_add_u32 m0, s59, 12288
    s_add_u32 s48, s57, 12288
    buffer_load_dwordx4 v3, s[60:63], s48 offen offset:0 sc1 lds
    buffer_load_dwordx4 v3, s[60:63], s48 offen offset:1024 sc1 lds
    buffer_load_dwordx4 v3, s[60:63], s48 offen offset:2048 sc1 lds
    buffer_load_dwordx4 v3, s[60:63], s48 offen offset:3072 sc1 lds
    ds_read_b128 v[48:51], v9 offset:0
    ds_read_b128 v[52:55], v10 offset:0
    ds_read_b128 v[56:59], v9 offset:1024
    ds_read_b128 v[60:63], v10 offset:1024
    s_waitcnt lgkmcnt(2)
    v_mfma_f32_32x32x16_bf16 v[16:31], v[64:67], v[48:51], 0
    v_mfma_f32_32x32x16_bf16 v[32:47], v[64:67], v[52:55], 0
    ds_read_b128 v[48:51], v9 offset:2048
    ds_read_b128 v[52:55], v10 offset:2048
    s_waitcnt lgkmcnt(2)
    v_mfma_f32_32x32x16_bf16 v[16:31], v[68:71], v[56:59], v[16:31]
    v_mfma_f32_32x32x16_bf16 v[32:47], v[68:71], v[60:63], v[32:47]
    ds_read_b128 v[56:59], v9 offset:3072
    ds_read_b128 v[60:63], v10 offset:3072
    s_waitcnt lgkmcnt(2)
    v_mfma_f32_32x32x16_bf16 v[16:31], v[72:75], v[48:51], v[16:31]
    v_mfma_f32_32x32x16_bf16 v[32:47], v[72:75], v[52:55], v[32:47]
    s_waitcnt lgkmcnt(0)
    v_mfma_f32_32x32x16_bf16 v[16:31], v[76:79], v[56:59], v[16:31]
    v_mfma_f32_32x32x16_bf16 v[32:47], v[76:79], v[60:63], v[32:47]
    s_waitcnt vmcnt(8)
    s_barrier
    s_add_u32 m0, s59, 16384
    s_add_u32 s48, s57, 16384
    buffer_load_dwordx4 v3, s[60:63], s48 offen offset:0 sc1 lds
    buffer_load_dwordx4 v3, s[60:63], s48 offen offset:1024 sc1 lds
    buffer_load_dwordx4 v3, s[60:63], s48 offen offset:2048 sc1 lds
    buffer_load_dwordx4 v3, s[60:63], s48 offen offset:3072 sc1 lds
    ds_read_b128 v[48:51], v9 offset:4096
    ds_read_b128 v[52:55], v10 offset:4096
    ds_read_b128 v[56:59], v9 offset:5120
    ds_read_b128 v[60:63], v10 offset:5120
    s_waitcnt lgkmcnt(2)
    v_mfma_f32_32x32x16_bf16 v[16:31], v[80:83], v[48:51], v[16:31]
    v_mfma_f32_32x32x16_bf16 v[32:47], v[80:83], v[52:55], v[32:47]
    ds_read_b128 v[48:51], v9 offset:6144
    ds_read_b128 v[52:55], v10 offset:6144
    s_waitcnt lgkmcnt(2)
    v_mfma_f32_32x32x16_bf16 v[16:31], v[84:87], v[56:59], v[16:31]
    v_mfma_f32_32x32x16_bf16 v[32:47], v[84:87], v[60:63], v[32:47]
    ds_read_b128 v[56:59], v9 offset:7168
    ds_read_b128 v[60:63], v10 offset:7168
    s_waitcnt lgkmcnt(2)
    v_mfma_f32_32x32x16_bf16 v[16:31], v[88:91], v[48:51], v[16:31]
    v_mfma_f32_32x32x16_bf16 v[32:47], v[88:91], v[52:55], v[32:47]
    s_waitcnt lgkmcnt(0)
    v_mfma_f32_32x32x16_bf16 v[16:31], v[92:95], v[56:59], v[16:31]
    v_mfma_f32_32x32x16_bf16 v[32:47], v[92:95], v[60:63], v[32:47]
    s_waitcnt vmcnt(8)
    s_barrier
    buffer_load_dwordx4 v[152:155], v3, s[60:63], s44 offen sc1
    buffer_load_dwordx4 v[160:163], v3, s[60:63], s44 offen offset:1024 sc1
    buffer_load_dwordx4 v[156:159], v3, s[60:63], s45 offen sc1
    buffer_load_dwordx4 v[164:167], v3, s[60:63], s45 offen offset:1024 sc1
    buffer_load_dwordx4 v[176:179], v3, s[60:63], s46 offen sc1
    ds_read_b128 v[48:51], v9 offset:8192
    ds_read_b128 v[52:55], v10 offset:8192
    ds_read_b128 v[56:59], v9 offset:9216
    ds_read_b128 v[60:63], v10 offset:9216
    s_waitcnt lgkmcnt(2)
    v_mfma_f32_32x32x16_bf16 v[16:31], v[96:99], v[48:51], v[16:31]
    v_mfma_f32_32x32x16_bf16 v[32:47], v[96:99], v[52:55], v[32:47]
    ds_read_b128 v[48:51], v9 offset:10240
    ds_read_b128 v[52:55], v10 offset:10240
    s_waitcnt lgkmcnt(2)
    v_mfma_f32_32x32x16_bf16 v[16:31], v[100:103], v[56:59], v[16:31]
    v_mfma_f32_32x32x16_bf16 v[32:47], v[100:103], v[60:63], v[32:47]
    ds_read_b128 v[56:59], v9 offset:11264
    ds_read_b128 v[60:63], v10 offset:11264
    s_waitcnt lgkmcnt(2)
    v_mfma_f32_32x32x16_bf16 v[16:31], v[104:107], v[48:51], v[16:31]
    v_mfma_f32_32x32x16_bf16 v[32:47], v[104:107], v[52:55], v[32:47]
    s_waitcnt lgkmcnt(0)
    v_mfma_f32_32x32x16_bf16 v[16:31], v[108:111], v[56:59], v[16:31]
    v_mfma_f32_32x32x16_bf16 v[32:47], v[108:111], v[60:63], v[32:47]
    s_waitcnt vmcnt(9)
    s_barrier
    ds_read_b128 v[48:51], v9 offset:12288
    ds_read_b128 v[52:55], v10 offset:12288
    ds_read_b128 v[56:59], v9 offset:13312
    ds_read_b128 v[60:63], v10 offset:13312
    s_waitcnt lgkmcnt(2)
    v_mfma_f32_32x32x16_bf16 v[16:31], v[112:115], v[48:51], v[16:31]
    v_mfma_f32_32x32x16_bf16 v[32:47], v[112:115], v[52:55], v[32:47]
    ds_read_b128 v[48:51], v9 offset:14336
    ds_read_b128 v[52:55], v10 offset:14336
    s_waitcnt lgkmcnt(2)
    v_mfma_f32_32x32x16_bf16 v[16:31], v[116:119], v[56:59], v[16:31]
    v_mfma_f32_32x32x16_bf16 v[32:47], v[116:119], v[60:63], v[32:47]
    ds_read_b128 v[56:59], v9 offset:15360
    ds_read_b128 v[60:63], v10 offset:15360
    s_waitcnt lgkmcnt(2)
    v_mfma_f32_32x32x16_bf16 v[16:31], v[120:123], v[48:51], v[16:31]
    v_mfma_f32_32x32x16_bf16 v[32:47], v[120:123], v[52:55], v[32:47]
    s_waitcnt lgkmcnt(0)
    v_mfma_f32_32x32x16_bf16 v[16:31], v[124:127], v[56:59], v[16:31]
    v_mfma_f32_32x32x16_bf16 v[32:47], v[124:127], v[60:63], v[32:47]
    s_waitcnt vmcnt(5)
    s_barrier
    ds_read_b128 v[48:51], v9 offset:16384
    ds_read_b128 v[52:55], v10 offset:16384
    ds_read_b128 v[56:59], v9 offset:17408
    ds_read_b128 v[60:63], v10 offset:17408
    s_waitcnt lgkmcnt(2)
    v_mfma_f32_32x32x16_bf16 v[16:31], v[128:131], v[48:51], v[16:31]
    v_mfma_f32_32x32x16_bf16 v[32:47], v[128:131], v[52:55], v[32:47]
    ds_read_b128 v[48:51], v9 offset:18432
    ds_read_b128 v[52:55], v10 offset:18432
    s_waitcnt lgkmcnt(2)
    v_mfma_f32_32x32x16_bf16 v[16:31], v[132:135], v[56:59], v[16:31]
    v_mfma_f32_32x32x16_bf16 v[32:47], v[132:135], v[60:63], v[32:47]
    ds_read_b128 v[56:59], v9 offset:19456
    ds_read_b128 v[60:63], v10 offset:19456
    s_waitcnt lgkmcnt(2)
    v_mfma_f32_32x32x16_bf16 v[16:31], v[136:139], v[48:51], v[16:31]
    v_mfma_f32_32x32x16_bf16 v[32:47], v[136:139], v[52:55], v[32:47]
    s_waitcnt lgkmcnt(0)
    v_mfma_f32_32x32x16_bf16 v[16:31], v[140:143], v[56:59], v[16:31]
    v_mfma_f32_32x32x16_bf16 v[32:47], v[140:143], v[60:63], v[32:47]
    s_waitcnt vmcnt(0)
    v_mfma_f32_32x32x16_bf16 v[16:31], v[144:147], v[152:155], v[16:31]
    v_mfma_f32_32x32x16_bf16 v[32:47], v[144:147], v[156:159], v[32:47]
    v_mfma_f32_32x32x16_bf16 v[16:31], v[148:151], v[160:163], v[16:31]
    v_mfma_f32_32x32x16_bf16 v[32:47], v[148:151], v[164:167], v[32:47]
    s_barrier
    v_lshlrev_b32 v48, 16, v176
    v_and_b32 v49, 0xffff0000, v176
    v_lshlrev_b32 v50, 16, v177
    v_and_b32 v51, 0xffff0000, v177
    v_lshlrev_b32 v52, 16, v178
    v_and_b32 v53, 0xffff0000, v178
    v_lshlrev_b32 v54, 16, v179
    v_and_b32 v55, 0xffff0000, v179
    s_nop 1
    ds_write_b128 v11, v[24:27]
    ds_write_b128 v11, v[28:31] offset:1024
    ds_write_b128 v12, v[32:35]
    ds_write_b128 v12, v[36:39] offset:1024
    ds_write_b128 v13, v[40:43]
    ds_write_b128 v13, v[44:47] offset:1024
    s_waitcnt lgkmcnt(0)
    s_barrier
    ds_read_b128 v[64:67], v14 offset:0
    ds_read_b128 v[68:71], v14 offset:1024
    ds_read_b128 v[72:75], v14 offset:2048
    ds_read_b128 v[76:79], v14 offset:3072
    ds_read_b128 v[80:83], v14 offset:4096
    ds_read_b128 v[84:87], v14 offset:5120
    s_waitcnt lgkmcnt(4)
    v_add_f32 v16, v16, v64
    v_add_f32 v17, v17, v65
    v_add_f32 v18, v18, v66
    v_add_f32 v19, v19, v67
    v_add_f32 v20, v20, v68
    v_add_f32 v21, v21, v69
    v_add_f32 v22, v22, v70
    v_add_f32 v23, v23, v71
    s_waitcnt lgkmcnt(2)
    v_add_f32 v16, v16, v72
    v_add_f32 v17, v17, v73
    v_add_f32 v18, v18, v74
    v_add_f32 v19, v19, v75
    v_add_f32 v20, v20, v76
    v_add_f32 v21, v21, v77
    v_add_f32 v22, v22, v78
    v_add_f32 v23, v23, v79
    s_waitcnt lgkmcnt(0)
    v_add_f32 v16, v16, v80
    v_add_f32 v17, v17, v81
    v_add_f32 v18, v18, v82
    v_add_f32 v19, v19, v83
    v_add_f32 v20, v20, v84
    v_add_f32 v21, v21, v85
    v_add_f32 v22, v22, v86
    v_add_f32 v23, v23, v87
    v_fma_f32 v16, v16, v168, v48
    v_fma_f32 v17, v17, v169, v49
    v_fma_f32 v18, v18, v170, v50
    v_fma_f32 v19, v19, v171, v51
    v_fma_f32 v20, v20, v172, v52
    v_fma_f32 v21, v21, v173, v53
    v_fma_f32 v22, v22, v174, v54
    v_fma_f32 v23, v23, v175, v55
    v_cvt_pk_bf16_f32 v56, v16, v17
    v_cvt_pk_bf16_f32 v57, v18, v19
    v_cvt_pk_bf16_f32 v58, v20, v21
    v_cvt_pk_bf16_f32 v59, v22, v23
    s_nop 0
    v_permlane32_swap_b32 v56, v58
    v_permlane32_swap_b32 v57, v59
    buffer_store_dwordx4 v[56:59], v7, s[8:11], s49 offen
PK_END:
    s_endpgm
PK_CODE_END:
.section .rodata,"a"
.p2align 6
.amdhsa_kernel adaLN_cond__mha_block__glu_gated_swiglu__prompt_kernel
  .amdhsa_next_free_vgpr 256
  .amdhsa_next_free_sgpr 100
  .amdhsa_accum_offset 256
  .amdhsa_group_segment_fixed_size 0
  .amdhsa_kernarg_size 96
  .amdhsa_user_sgpr_count 2
  .amdhsa_user_sgpr_kernarg_segment_ptr 1
  .amdhsa_system_sgpr_workgroup_id_x 1
.end_amdhsa_kernel
```
